```python
import torch

def _softmax(x, axis=-1):
    return torch.softmax(x, dim=axis)
def _gelu(x):
    return torch.nn.functional.gelu(x, approximate="tanh")
def _silu(x):
    return torch.nn.functional.silu(x)
def _sigmoid(x):
    return torch.sigmoid(x)
def _layernorm(x, axis=-1, eps=1e-5):
    m = x.mean(dim=axis, keepdim=True)
    v = x.var(dim=axis, keepdim=True, unbiased=False)
    return (x - m) / torch.sqrt(v + eps)
def _scatter_add(tgt, idx, src, axis=0):
    return tgt.clone().index_add_(axis, idx, src)
def _segment_sum(src, seg, n):
    out = torch.zeros((n,) + src.shape[1:], dtype=src.dtype)
    return out.index_add_(0, seg, src)
def _pad(x, pw):
    flat = tuple(v for pair in reversed(pw) for v in pair)
    return torch.nn.functional.pad(x, flat)

kernel_name = 'standalone__gqa_softmax__near_ridge'

def setup_inputs():

    _w = (lambda a: (lambda t: t.to(torch.bfloat16) if t.is_floating_point() else t)(torch.as_tensor(a)))
    B, Hq, Hkv, Sq, Sk, D = 8, 32, 32, 256, 2048, 128
    return {
        "q": _w((lambda *s: torch.randn(*s, dtype=torch.bfloat16) * 0.8)(B, Hq, Sq, D)),
        "k": _w((lambda *s: torch.randn(*s, dtype=torch.bfloat16) * 0.8)(B, Hkv, Sk, D)),
        "v": _w((lambda *s: torch.randn(*s, dtype=torch.bfloat16) * 0.05)(B, Hkv, Sk, D)),
    }

def reference(q, k, v):
    B, Hq, Sq, D = q.shape
    Hkv = k.shape[1]
    rep = Hq // Hkv
    k = (lambda x, n, axis: torch.repeat_interleave(x, n, dim=axis))(k, rep, axis=1)
    v = (lambda x, n, axis: torch.repeat_interleave(x, n, dim=axis))(v, rep, axis=1)
    scale = D ** -0.5
    scores = torch.einsum("bhqd,bhkd->bhqk", q, k) * scale
    p = _softmax(scores, axis=-1)
    return torch.einsum("bhqk,bhkd->bhqd", p, v)
```

```asm
; @launch grid=(256,1,1) block=(256,1,1) lds=163840
.amdgcn_target "amdgcn-amd-amdhsa--gfx950"
.text
.globl standalone__gqa_softmax__near_ridge_kernel
.p2align 8
.type standalone__gqa_softmax__near_ridge_kernel,@function
standalone__gqa_softmax__near_ridge_kernel:
    s_cmp_ge_u32 s2, 0x100
    s_cbranch_scc1 L_end
    s_load_dwordx8 s[4:11], s[0:1], 0
    s_getpc_b64 s[44:45]
L_pc:
    v_lshlrev_b32 v25, 7, v0
    v_min_u32 v25, (L_hotend-L_pc), v25
    global_load_dword v228, v25, s[44:45]
    v_lshrrev_b32 v20, 6, v0
    v_and_b32 v0, 63, v0
    v_readfirstlane_b32 s28, v20
    s_getreg_b32 s41, hwreg(HW_REG_XCC_ID, 0, 1)
    s_cmp_eq_u32 s41, 0
    s_mov_b32 s41, 0x0
    s_cselect_b32 s41, 0x65436543, s41
    s_lshr_b32 s32, s2, 1
    s_and_b32 s32, s32, 0x1c
    s_lshr_b32 s41, s41, s32
    s_and_b32 s41, s41, 15
    v_lshrrev_b32 v20, 4, v0
    v_and_b32 v21, 15, v0
    s_lshr_b32 s33, s28, 1
    s_and_b32 s32, s28, 1
    s_lshl_b32 s32, s32, 12
    v_lshlrev_b32 v22, 8, v20
    v_add_u32 v22, s32, v22
    v_xor_b32 v23, v20, v21
    v_lshl_add_u32 v13, v23, 4, v22
    s_cmp_eq_u32 s33, 0
    s_cselect_b32 s31, 64, 0x80
    v_xor_b32 v14, s31, v13
    s_cselect_b32 s31, 0x80, 0
    v_xor_b32 v15, s31, v13
    v_xor_b32 v16, s31, v14
    s_mul_i32 s30, s33, 0xc000
    s_add_u32 s30, s30, s32
    s_add_u32 s50, s30, 0x4000
    s_add_u32 s51, s30, 0x6000
    s_add_u32 s52, s30, 0x8000
    s_add_u32 s53, s30, 0xa000
    s_add_u32 s54, s30, 0xc000
    s_add_u32 s55, s30, 0xe000
    s_lshl_b32 s31, s33, 16
    s_add_u32 s48, s30, s31
    s_add_u32 s49, s48, 0x2000
    s_lshl_b32 s43, s28, 12
    s_add_u32 s43, s43, 0x20000
    s_lshl_b32 s31, s28, 14
    v_lshlrev_b32 v22, 8, v21
    v_lshl_add_u32 v22, v20, 4, v22
    v_add_u32 v17, s31, v22
    s_movk_i32 s36, 0x0
    s_movk_i32 s37, 0x1000
    s_movk_i32 s38, 0x2000
    s_movk_i32 s39, 0x3000
    s_mov_b32 s18, 0x80000
    s_mov_b32 s19, 0x20000
    s_mov_b32 s14, 0x10000
    s_mov_b32 s15, 0x20000
    s_mov_b32 s22, 0x10000
    s_mov_b32 s23, 0x20000
    s_lshl_b32 s47, s2, 19
    s_lshl_b32 s31, s2, 16
    s_cmp_eq_u32 s33, 0
    s_waitcnt lgkmcnt(0)
    s_cselect_b32 s16, s6, s8
    s_cselect_b32 s17, s7, s9
    s_add_u32 s16, s16, s47
    s_addc_u32 s17, s17, 0
    s_add_u32 s12, s4, s31
    s_addc_u32 s13, s5, 0
    s_add_u32 s20, s10, s31
    s_addc_u32 s21, s11, 0
    s_mov_b32 m0, s48
    s_cmp_eq_u32 s33, 0
    s_cselect_b32 s42, 0x0, s18
    buffer_load_dwordx4 v13, s[16:19], s42 offen offset:0 nt lds
    buffer_load_dwordx4 v14, s[16:19], s42 offen offset:1024 nt lds
    buffer_load_dwordx4 v15, s[16:19], s42 offen offset:2048 nt lds
    buffer_load_dwordx4 v16, s[16:19], s42 offen offset:3072 nt lds
    s_mov_b32 m0, s49
    s_cmp_eq_u32 s33, 0
    s_cselect_b32 s42, 0x2000, s18
    buffer_load_dwordx4 v13, s[16:19], s42 offen offset:0 nt lds
    buffer_load_dwordx4 v14, s[16:19], s42 offen offset:1024 nt lds
    buffer_load_dwordx4 v15, s[16:19], s42 offen offset:2048 nt lds
    buffer_load_dwordx4 v16, s[16:19], s42 offen offset:3072 nt lds
    s_cmp_lt_u32 s41, 1
    s_cbranch_scc1 L_predone
    s_lshl_b32 s42, s33, 14
    s_sub_u32 s42, 0x4000, s42
    s_mov_b32 m0, s50
    s_nop 0
    buffer_load_dwordx4 v13, s[16:19], s42 offen offset:0 nt lds
    buffer_load_dwordx4 v14, s[16:19], s42 offen offset:1024 nt lds
    buffer_load_dwordx4 v15, s[16:19], s42 offen offset:2048 nt lds
    buffer_load_dwordx4 v16, s[16:19], s42 offen offset:3072 nt lds
    s_cmp_lt_u32 s41, 2
    s_cbranch_scc1 L_predone
    s_lshl_b32 s42, s33, 14
    s_sub_u32 s42, 0x6000, s42
    s_mov_b32 m0, s51
    s_nop 0
    buffer_load_dwordx4 v13, s[16:19], s42 offen offset:0 nt lds
    buffer_load_dwordx4 v14, s[16:19], s42 offen offset:1024 nt lds
    buffer_load_dwordx4 v15, s[16:19], s42 offen offset:2048 nt lds
    buffer_load_dwordx4 v16, s[16:19], s42 offen offset:3072 nt lds
    s_cmp_lt_u32 s41, 3
    s_cbranch_scc1 L_predone
    s_lshl_b32 s42, s33, 14
    s_sub_u32 s42, 0x8000, s42
    s_mov_b32 m0, s52
    s_nop 0
    buffer_load_dwordx4 v13, s[16:19], s42 offen offset:0 nt lds
    buffer_load_dwordx4 v14, s[16:19], s42 offen offset:1024 nt lds
    buffer_load_dwordx4 v15, s[16:19], s42 offen offset:2048 nt lds
    buffer_load_dwordx4 v16, s[16:19], s42 offen offset:3072 nt lds
    s_cmp_lt_u32 s41, 4
    s_cbranch_scc1 L_predone
    s_lshl_b32 s42, s33, 14
    s_sub_u32 s42, 0xa000, s42
    s_mov_b32 m0, s53
    s_nop 0
    buffer_load_dwordx4 v13, s[16:19], s42 offen offset:0 nt lds
    buffer_load_dwordx4 v14, s[16:19], s42 offen offset:1024 nt lds
    buffer_load_dwordx4 v15, s[16:19], s42 offen offset:2048 nt lds
    buffer_load_dwordx4 v16, s[16:19], s42 offen offset:3072 nt lds
    s_cmp_lt_u32 s41, 5
    s_cbranch_scc1 L_predone
    s_lshl_b32 s42, s33, 14
    s_sub_u32 s42, 0xc000, s42
    s_mov_b32 m0, s54
    s_nop 0
    buffer_load_dwordx4 v13, s[16:19], s42 offen offset:0 nt lds
    buffer_load_dwordx4 v14, s[16:19], s42 offen offset:1024 nt lds
    buffer_load_dwordx4 v15, s[16:19], s42 offen offset:2048 nt lds
    buffer_load_dwordx4 v16, s[16:19], s42 offen offset:3072 nt lds
    s_cmp_lt_u32 s41, 6
    s_cbranch_scc1 L_predone
    s_lshl_b32 s42, s33, 14
    s_sub_u32 s42, 0xe000, s42
    s_mov_b32 m0, s55
    s_nop 0
    buffer_load_dwordx4 v13, s[16:19], s42 offen offset:0 nt lds
    buffer_load_dwordx4 v14, s[16:19], s42 offen offset:1024 nt lds
    buffer_load_dwordx4 v15, s[16:19], s42 offen offset:2048 nt lds
    buffer_load_dwordx4 v16, s[16:19], s42 offen offset:3072 nt lds
L_predone:
    buffer_load_dwordx4 v[160:163], v17, s[12:15], s36 offen offset:0 nt
    buffer_load_dwordx4 v[164:167], v17, s[12:15], s36 offen offset:64 nt
    buffer_load_dwordx4 v[168:171], v17, s[12:15], s36 offen offset:128 nt
    buffer_load_dwordx4 v[172:175], v17, s[12:15], s36 offen offset:192 nt
    buffer_load_dwordx4 v[176:179], v17, s[12:15], s37 offen offset:0 nt
    buffer_load_dwordx4 v[180:183], v17, s[12:15], s37 offen offset:64 nt
    buffer_load_dwordx4 v[184:187], v17, s[12:15], s37 offen offset:128 nt
    buffer_load_dwordx4 v[188:191], v17, s[12:15], s37 offen offset:192 nt
    v_xor_b32 v24, v21, v20
    v_lshlrev_b32 v25, 8, v21
    v_lshl_add_u32 v1, v24, 4, v25
    v_xor_b32 v2, 64, v1
    v_xor_b32 v3, 128, v1
    v_xor_b32 v4, 192, v1
    v_lshrrev_b32 v24, 2, v0
    v_lshlrev_b32 v25, 8, v24
    v_and_b32 v24, 3, v24
    v_lshl_add_u32 v25, v24, 4, v25
    v_bfe_u32 v24, v0, 4, 1
    v_lshl_add_u32 v25, v24, 7, v25
    v_bfe_u32 v24, v0, 1, 1
    v_lshl_add_u32 v25, v24, 6, v25
    v_and_b32 v24, 1, v0
    v_lshl_add_u32 v25, v24, 3, v25
    v_add_u32 v5, 0x10000, v25
    v_xor_b32 v6, 16, v5
    v_xor_b32 v7, 32, v5
    v_xor_b32 v8, 48, v5
    v_xor_b32 v9, 128, v5
    v_xor_b32 v10, 144, v5
    v_xor_b32 v11, 160, v5
    v_xor_b32 v12, 176, v5
    s_lshl_b32 s32, s28, 13
    s_add_u32 s32, s32, 0x20000
    v_and_b32 v24, 15, v0
    v_lshrrev_b32 v25, 4, v0
    v_lshlrev_b32 v150, 10, v25
    v_lshl_add_u32 v152, v24, 4, v150
    v_and_b32 v25, 1, v25
    v_lshlrev_b32 v25, 6, v25
    v_xor_b32 v148, v152, v25
    v_add_u32 v148, s32, v148
    v_add_u32 v150, v150, v25
    v_and_b32 v24, 1, v0
    v_lshl_add_u32 v150, v24, 7, v150
    v_bfe_u32 v24, v0, 2, 2
    v_lshl_add_u32 v150, v24, 4, v150
    v_bfe_u32 v24, v0, 1, 1
    v_lshl_add_u32 v150, v24, 3, v150
    v_add_u32 v150, s32, v150
    v_xor_b32 v151, 64, v150
    s_lshl_b32 s31, s28, 14
    v_add_u32 v152, s31, v152
    v_and_b32 v24, 3, v0
    v_accvgpr_write_b32 a0, 0
    v_accvgpr_write_b32 a1, 0
    v_accvgpr_write_b32 a2, 0
    v_accvgpr_write_b32 a3, 0
    v_accvgpr_write_b32 a4, 0
    v_accvgpr_write_b32 a5, 0
    v_accvgpr_write_b32 a6, 0
    v_accvgpr_write_b32 a7, 0
    v_accvgpr_write_b32 a8, 0
    v_accvgpr_write_b32 a9, 0
    v_accvgpr_write_b32 a10, 0
    v_accvgpr_write_b32 a11, 0
    v_accvgpr_write_b32 a12, 0
    v_accvgpr_write_b32 a13, 0
    v_accvgpr_write_b32 a14, 0
    v_accvgpr_write_b32 a15, 0
    v_accvgpr_write_b32 a16, 0
    v_accvgpr_write_b32 a17, 0
    v_accvgpr_write_b32 a18, 0
    v_accvgpr_write_b32 a19, 0
    v_accvgpr_write_b32 a20, 0
    v_accvgpr_write_b32 a21, 0
    v_accvgpr_write_b32 a22, 0
    v_accvgpr_write_b32 a23, 0
    v_accvgpr_write_b32 a24, 0
    v_accvgpr_write_b32 a25, 0
    v_accvgpr_write_b32 a26, 0
    v_accvgpr_write_b32 a27, 0
    v_accvgpr_write_b32 a28, 0
    v_accvgpr_write_b32 a29, 0
    v_accvgpr_write_b32 a30, 0
    v_accvgpr_write_b32 a31, 0
    v_accvgpr_write_b32 a32, 0
    v_accvgpr_write_b32 a33, 0
    v_accvgpr_write_b32 a34, 0
    v_accvgpr_write_b32 a35, 0
    v_accvgpr_write_b32 a36, 0
    v_accvgpr_write_b32 a37, 0
    v_accvgpr_write_b32 a38, 0
    v_accvgpr_write_b32 a39, 0
    v_accvgpr_write_b32 a40, 0
    v_accvgpr_write_b32 a41, 0
    v_accvgpr_write_b32 a42, 0
    v_accvgpr_write_b32 a43, 0
    v_accvgpr_write_b32 a44, 0
    v_accvgpr_write_b32 a45, 0
    v_accvgpr_write_b32 a46, 0
    v_accvgpr_write_b32 a47, 0
    v_accvgpr_write_b32 a48, 0
    v_accvgpr_write_b32 a49, 0
    v_accvgpr_write_b32 a50, 0
    v_accvgpr_write_b32 a51, 0
    v_accvgpr_write_b32 a52, 0
    v_accvgpr_write_b32 a53, 0
    v_accvgpr_write_b32 a54, 0
    v_accvgpr_write_b32 a55, 0
    v_accvgpr_write_b32 a56, 0
    v_accvgpr_write_b32 a57, 0
    v_accvgpr_write_b32 a58, 0
    v_accvgpr_write_b32 a59, 0
    v_accvgpr_write_b32 a60, 0
    v_accvgpr_write_b32 a61, 0
    v_accvgpr_write_b32 a62, 0
    v_accvgpr_write_b32 a63, 0
    v_accvgpr_write_b32 a64, 0
    v_accvgpr_write_b32 a65, 0
    v_accvgpr_write_b32 a66, 0
    v_accvgpr_write_b32 a67, 0
    v_accvgpr_write_b32 a68, 0
    v_accvgpr_write_b32 a69, 0
    v_accvgpr_write_b32 a70, 0
    v_accvgpr_write_b32 a71, 0
    v_accvgpr_write_b32 a72, 0
    v_accvgpr_write_b32 a73, 0
    v_accvgpr_write_b32 a74, 0
    v_accvgpr_write_b32 a75, 0
    v_accvgpr_write_b32 a76, 0
    v_accvgpr_write_b32 a77, 0
    v_accvgpr_write_b32 a78, 0
    v_accvgpr_write_b32 a79, 0
    v_accvgpr_write_b32 a80, 0
    v_accvgpr_write_b32 a81, 0
    v_accvgpr_write_b32 a82, 0
    v_accvgpr_write_b32 a83, 0
    v_accvgpr_write_b32 a84, 0
    v_accvgpr_write_b32 a85, 0
    v_accvgpr_write_b32 a86, 0
    v_accvgpr_write_b32 a87, 0
    v_accvgpr_write_b32 a88, 0
    v_accvgpr_write_b32 a89, 0
    v_accvgpr_write_b32 a90, 0
    v_accvgpr_write_b32 a91, 0
    v_accvgpr_write_b32 a92, 0
    v_accvgpr_write_b32 a93, 0
    v_accvgpr_write_b32 a94, 0
    v_accvgpr_write_b32 a95, 0
    v_accvgpr_write_b32 a96, 0
    v_accvgpr_write_b32 a97, 0
    v_accvgpr_write_b32 a98, 0
    v_accvgpr_write_b32 a99, 0
    v_accvgpr_write_b32 a100, 0
    v_accvgpr_write_b32 a101, 0
    v_accvgpr_write_b32 a102, 0
    v_accvgpr_write_b32 a103, 0
    v_accvgpr_write_b32 a104, 0
    v_accvgpr_write_b32 a105, 0
    v_accvgpr_write_b32 a106, 0
    v_accvgpr_write_b32 a107, 0
    v_accvgpr_write_b32 a108, 0
    v_accvgpr_write_b32 a109, 0
    v_accvgpr_write_b32 a110, 0
    v_accvgpr_write_b32 a111, 0
    v_accvgpr_write_b32 a112, 0
    v_accvgpr_write_b32 a113, 0
    v_accvgpr_write_b32 a114, 0
    v_accvgpr_write_b32 a115, 0
    v_accvgpr_write_b32 a116, 0
    v_accvgpr_write_b32 a117, 0
    v_accvgpr_write_b32 a118, 0
    v_accvgpr_write_b32 a119, 0
    v_accvgpr_write_b32 a120, 0
    v_accvgpr_write_b32 a121, 0
    v_accvgpr_write_b32 a122, 0
    v_accvgpr_write_b32 a123, 0
    v_accvgpr_write_b32 a124, 0
    v_accvgpr_write_b32 a125, 0
    v_accvgpr_write_b32 a126, 0
    v_accvgpr_write_b32 a127, 0
    v_mov_b32 v144, 0
    v_mov_b32 v145, 0
    v_mov_b32 v146, 0
    v_mov_b32 v147, 0
    v_mov_b32 v25, 0x3f803f80
    v_cmp_eq_u32 vcc, 0, v24
    s_nop 1
    v_cndmask_b32 v22, 0, v25, vcc
    v_accvgpr_write_b32 a160, v22
    v_accvgpr_write_b32 a161, v22
    v_accvgpr_write_b32 a162, v22
    v_accvgpr_write_b32 a163, v22
    v_cmp_eq_u32 vcc, 1, v24
    s_nop 1
    v_cndmask_b32 v22, 0, v25, vcc
    v_accvgpr_write_b32 a164, v22
    v_accvgpr_write_b32 a165, v22
    v_accvgpr_write_b32 a166, v22
    v_accvgpr_write_b32 a167, v22
    v_cmp_eq_u32 vcc, 2, v24
    s_nop 1
    v_cndmask_b32 v22, 0, v25, vcc
    v_accvgpr_write_b32 a168, v22
    v_accvgpr_write_b32 a169, v22
    v_accvgpr_write_b32 a170, v22
    v_accvgpr_write_b32 a171, v22
    v_cmp_eq_u32 vcc, 3, v24
    s_nop 1
    v_cndmask_b32 v22, 0, v25, vcc
    v_accvgpr_write_b32 a172, v22
    v_accvgpr_write_b32 a173, v22
    v_accvgpr_write_b32 a174, v22
    v_accvgpr_write_b32 a175, v22
    s_mov_b32 s34, 0x3e0293ee
    s_mov_b32 s35, 0x3e0293ee
    s_mov_b32 s46, 0xffff0000
    buffer_load_dwordx4 v[192:195], v17, s[12:15], s38 offen offset:0 nt
    buffer_load_dwordx4 v[196:199], v17, s[12:15], s38 offen offset:64 nt
    buffer_load_dwordx4 v[200:203], v17, s[12:15], s38 offen offset:128 nt
    buffer_load_dwordx4 v[204:207], v17, s[12:15], s38 offen offset:192 nt
    buffer_load_dwordx4 v[208:211], v17, s[12:15], s39 offen offset:0 nt
    buffer_load_dwordx4 v[212:215], v17, s[12:15], s39 offen offset:64 nt
    buffer_load_dwordx4 v[216:219], v17, s[12:15], s39 offen offset:128 nt
    buffer_load_dwordx4 v[220:223], v17, s[12:15], s39 offen offset:192 nt
    s_waitcnt vmcnt(12)
    v_lshlrev_b32 v20, 16, v160
    v_and_b32 v21, s46, v160
    v_lshlrev_b32 v22, 16, v161
    v_and_b32 v23, s46, v161
    v_lshlrev_b32 v24, 16, v162
    v_and_b32 v25, s46, v162
    v_lshlrev_b32 v26, 16, v163
    v_and_b32 v27, s46, v163
    v_pk_mul_f32 v[20:21], v[20:21], s[34:35]
    v_pk_mul_f32 v[22:23], v[22:23], s[34:35]
    v_pk_mul_f32 v[24:25], v[24:25], s[34:35]
    v_pk_mul_f32 v[26:27], v[26:27], s[34:35]
    v_cvt_pk_bf16_f32 v160, v20, v21
    v_cvt_pk_bf16_f32 v161, v22, v23
    v_cvt_pk_bf16_f32 v162, v24, v25
    v_cvt_pk_bf16_f32 v163, v26, v27
    v_lshlrev_b32 v20, 16, v164
    v_and_b32 v21, s46, v164
    v_lshlrev_b32 v22, 16, v165
    v_and_b32 v23, s46, v165
    v_lshlrev_b32 v24, 16, v166
    v_and_b32 v25, s46, v166
    v_lshlrev_b32 v26, 16, v167
    v_and_b32 v27, s46, v167
    v_pk_mul_f32 v[20:21], v[20:21], s[34:35]
    v_pk_mul_f32 v[22:23], v[22:23], s[34:35]
    v_pk_mul_f32 v[24:25], v[24:25], s[34:35]
    v_pk_mul_f32 v[26:27], v[26:27], s[34:35]
    v_cvt_pk_bf16_f32 v164, v20, v21
    v_cvt_pk_bf16_f32 v165, v22, v23
    v_cvt_pk_bf16_f32 v166, v24, v25
    v_cvt_pk_bf16_f32 v167, v26, v27
    v_lshlrev_b32 v20, 16, v168
    v_and_b32 v21, s46, v168
    v_lshlrev_b32 v22, 16, v169
    v_and_b32 v23, s46, v169
    v_lshlrev_b32 v24, 16, v170
    v_and_b32 v25, s46, v170
    v_lshlrev_b32 v26, 16, v171
    v_and_b32 v27, s46, v171
    v_pk_mul_f32 v[20:21], v[20:21], s[34:35]
    v_pk_mul_f32 v[22:23], v[22:23], s[34:35]
    v_pk_mul_f32 v[24:25], v[24:25], s[34:35]
    v_pk_mul_f32 v[26:27], v[26:27], s[34:35]
    v_cvt_pk_bf16_f32 v168, v20, v21
    v_cvt_pk_bf16_f32 v169, v22, v23
    v_cvt_pk_bf16_f32 v170, v24, v25
    v_cvt_pk_bf16_f32 v171, v26, v27
    v_lshlrev_b32 v20, 16, v172
    v_and_b32 v21, s46, v172
    v_lshlrev_b32 v22, 16, v173
    v_and_b32 v23, s46, v173
    v_lshlrev_b32 v24, 16, v174
    v_and_b32 v25, s46, v174
    v_lshlrev_b32 v26, 16, v175
    v_and_b32 v27, s46, v175
    v_pk_mul_f32 v[20:21], v[20:21], s[34:35]
    v_pk_mul_f32 v[22:23], v[22:23], s[34:35]
    v_pk_mul_f32 v[24:25], v[24:25], s[34:35]
    v_pk_mul_f32 v[26:27], v[26:27], s[34:35]
    v_cvt_pk_bf16_f32 v172, v20, v21
    v_cvt_pk_bf16_f32 v173, v22, v23
    v_cvt_pk_bf16_f32 v174, v24, v25
    v_cvt_pk_bf16_f32 v175, v26, v27
    s_cmp_ge_u32 s41, 2
    s_cbranch_scc1 L_ql1
    s_lshl_b32 s42, s33, 14
    s_sub_u32 s42, 0x4000, s42
    s_cmp_ge_u32 s41, 1
    s_cselect_b32 s42, s18, s42
    s_cselect_b32 m0, s43, s50
    s_nop 0
    buffer_load_dwordx4 v13, s[16:19], s42 offen offset:0 nt lds
    buffer_load_dwordx4 v14, s[16:19], s42 offen offset:1024 nt lds
    buffer_load_dwordx4 v15, s[16:19], s42 offen offset:2048 nt lds
    buffer_load_dwordx4 v16, s[16:19], s42 offen offset:3072 nt lds
    s_waitcnt vmcnt(12)
    s_branch L_qj1
L_ql1:
    s_waitcnt vmcnt(8)
L_qj1:
    v_lshlrev_b32 v20, 16, v176
    v_and_b32 v21, s46, v176
    v_lshlrev_b32 v22, 16, v177
    v_and_b32 v23, s46, v177
    v_lshlrev_b32 v24, 16, v178
    v_and_b32 v25, s46, v178
    v_lshlrev_b32 v26, 16, v179
    v_and_b32 v27, s46, v179
    v_pk_mul_f32 v[20:21], v[20:21], s[34:35]
    v_pk_mul_f32 v[22:23], v[22:23], s[34:35]
    v_pk_mul_f32 v[24:25], v[24:25], s[34:35]
    v_pk_mul_f32 v[26:27], v[26:27], s[34:35]
    v_cvt_pk_bf16_f32 v176, v20, v21
    v_cvt_pk_bf16_f32 v177, v22, v23
    v_cvt_pk_bf16_f32 v178, v24, v25
    v_cvt_pk_bf16_f32 v179, v26, v27
    v_lshlrev_b32 v20, 16, v180
    v_and_b32 v21, s46, v180
    v_lshlrev_b32 v22, 16, v181
    v_and_b32 v23, s46, v181
    v_lshlrev_b32 v24, 16, v182
    v_and_b32 v25, s46, v182
    v_lshlrev_b32 v26, 16, v183
    v_and_b32 v27, s46, v183
    v_pk_mul_f32 v[20:21], v[20:21], s[34:35]
    v_pk_mul_f32 v[22:23], v[22:23], s[34:35]
    v_pk_mul_f32 v[24:25], v[24:25], s[34:35]
    v_pk_mul_f32 v[26:27], v[26:27], s[34:35]
    v_cvt_pk_bf16_f32 v180, v20, v21
    v_cvt_pk_bf16_f32 v181, v22, v23
    v_cvt_pk_bf16_f32 v182, v24, v25
    v_cvt_pk_bf16_f32 v183, v26, v27
    v_lshlrev_b32 v20, 16, v184
    v_and_b32 v21, s46, v184
    v_lshlrev_b32 v22, 16, v185
    v_and_b32 v23, s46, v185
    v_lshlrev_b32 v24, 16, v186
    v_and_b32 v25, s46, v186
    v_lshlrev_b32 v26, 16, v187
    v_and_b32 v27, s46, v187
    v_pk_mul_f32 v[20:21], v[20:21], s[34:35]
    v_pk_mul_f32 v[22:23], v[22:23], s[34:35]
    v_pk_mul_f32 v[24:25], v[24:25], s[34:35]
    v_pk_mul_f32 v[26:27], v[26:27], s[34:35]
    v_cvt_pk_bf16_f32 v184, v20, v21
    v_cvt_pk_bf16_f32 v185, v22, v23
    v_cvt_pk_bf16_f32 v186, v24, v25
    v_cvt_pk_bf16_f32 v187, v26, v27
    v_lshlrev_b32 v20, 16, v188
    v_and_b32 v21, s46, v188
    v_lshlrev_b32 v22, 16, v189
    v_and_b32 v23, s46, v189
    v_lshlrev_b32 v24, 16, v190
    v_and_b32 v25, s46, v190
    v_lshlrev_b32 v26, 16, v191
    v_and_b32 v27, s46, v191
    v_pk_mul_f32 v[20:21], v[20:21], s[34:35]
    v_pk_mul_f32 v[22:23], v[22:23], s[34:35]
    v_pk_mul_f32 v[24:25], v[24:25], s[34:35]
    v_pk_mul_f32 v[26:27], v[26:27], s[34:35]
    v_cvt_pk_bf16_f32 v188, v20, v21
    v_cvt_pk_bf16_f32 v189, v22, v23
    v_cvt_pk_bf16_f32 v190, v24, v25
    v_cvt_pk_bf16_f32 v191, v26, v27
    s_barrier
    ds_read_b128 a[128:131], v1 offset:0
    ds_read_b128 a[132:135], v2 offset:0
    ds_read_b128 a[136:139], v3 offset:0
    ds_read_b128 a[140:143], v4 offset:0
    s_cmp_ge_u32 s41, 2
    s_cbranch_scc1 L_ql2
    s_lshl_b32 s42, s33, 14
    s_sub_u32 s42, 0x6000, s42
    s_cmp_ge_u32 s41, 2
    s_cselect_b32 s42, s18, s42
    s_cselect_b32 m0, s43, s51
    s_nop 0
    buffer_load_dwordx4 v13, s[16:19], s42 offen offset:0 nt lds
    buffer_load_dwordx4 v14, s[16:19], s42 offen offset:1024 nt lds
    buffer_load_dwordx4 v15, s[16:19], s42 offen offset:2048 nt lds
    buffer_load_dwordx4 v16, s[16:19], s42 offen offset:3072 nt lds
    s_waitcnt vmcnt(12)
    s_branch L_qj2
L_ql2:
    s_waitcnt vmcnt(4)
L_qj2:
    v_lshlrev_b32 v20, 16, v192
    v_and_b32 v21, s46, v192
    v_lshlrev_b32 v22, 16, v193
    v_and_b32 v23, s46, v193
    v_lshlrev_b32 v24, 16, v194
    v_and_b32 v25, s46, v194
    v_lshlrev_b32 v26, 16, v195
    v_and_b32 v27, s46, v195
    v_pk_mul_f32 v[20:21], v[20:21], s[34:35]
    v_pk_mul_f32 v[22:23], v[22:23], s[34:35]
    v_pk_mul_f32 v[24:25], v[24:25], s[34:35]
    v_pk_mul_f32 v[26:27], v[26:27], s[34:35]
    v_cvt_pk_bf16_f32 v192, v20, v21
    v_cvt_pk_bf16_f32 v193, v22, v23
    v_cvt_pk_bf16_f32 v194, v24, v25
    v_cvt_pk_bf16_f32 v195, v26, v27
    v_lshlrev_b32 v20, 16, v196
    v_and_b32 v21, s46, v196
    v_lshlrev_b32 v22, 16, v197
    v_and_b32 v23, s46, v197
    v_lshlrev_b32 v24, 16, v198
    v_and_b32 v25, s46, v198
    v_lshlrev_b32 v26, 16, v199
    v_and_b32 v27, s46, v199
    v_pk_mul_f32 v[20:21], v[20:21], s[34:35]
    v_pk_mul_f32 v[22:23], v[22:23], s[34:35]
    v_pk_mul_f32 v[24:25], v[24:25], s[34:35]
    v_pk_mul_f32 v[26:27], v[26:27], s[34:35]
    v_cvt_pk_bf16_f32 v196, v20, v21
    v_cvt_pk_bf16_f32 v197, v22, v23
    v_cvt_pk_bf16_f32 v198, v24, v25
    v_cvt_pk_bf16_f32 v199, v26, v27
    v_lshlrev_b32 v20, 16, v200
    v_and_b32 v21, s46, v200
    v_lshlrev_b32 v22, 16, v201
    v_and_b32 v23, s46, v201
    v_lshlrev_b32 v24, 16, v202
    v_and_b32 v25, s46, v202
    v_lshlrev_b32 v26, 16, v203
    v_and_b32 v27, s46, v203
    v_pk_mul_f32 v[20:21], v[20:21], s[34:35]
    v_pk_mul_f32 v[22:23], v[22:23], s[34:35]
    v_pk_mul_f32 v[24:25], v[24:25], s[34:35]
    v_pk_mul_f32 v[26:27], v[26:27], s[34:35]
    v_cvt_pk_bf16_f32 v200, v20, v21
    v_cvt_pk_bf16_f32 v201, v22, v23
    v_cvt_pk_bf16_f32 v202, v24, v25
    v_cvt_pk_bf16_f32 v203, v26, v27
    v_lshlrev_b32 v20, 16, v204
    v_and_b32 v21, s46, v204
    v_lshlrev_b32 v22, 16, v205
    v_and_b32 v23, s46, v205
    v_lshlrev_b32 v24, 16, v206
    v_and_b32 v25, s46, v206
    v_lshlrev_b32 v26, 16, v207
    v_and_b32 v27, s46, v207
    v_pk_mul_f32 v[20:21], v[20:21], s[34:35]
    v_pk_mul_f32 v[22:23], v[22:23], s[34:35]
    v_pk_mul_f32 v[24:25], v[24:25], s[34:35]
    v_pk_mul_f32 v[26:27], v[26:27], s[34:35]
    v_cvt_pk_bf16_f32 v204, v20, v21
    v_cvt_pk_bf16_f32 v205, v22, v23
    v_cvt_pk_bf16_f32 v206, v24, v25
    v_cvt_pk_bf16_f32 v207, v26, v27
    s_waitcnt lgkmcnt(0)
    v_mfma_f32_16x16x32_bf16 v[32:35], a[128:131], v[160:163], 0
    v_mfma_f32_16x16x32_bf16 v[32:35], a[132:135], v[164:167], v[32:35]
    v_mfma_f32_16x16x32_bf16 v[32:35], a[136:139], v[168:171], v[32:35]
    v_mfma_f32_16x16x32_bf16 v[32:35], a[140:143], v[172:175], v[32:35]
    v_mfma_f32_16x16x32_bf16 v[36:39], a[140:143], v[188:191], 0
    v_mfma_f32_16x16x32_bf16 v[36:39], a[136:139], v[184:187], v[36:39]
    v_mfma_f32_16x16x32_bf16 v[36:39], a[132:135], v[180:183], v[36:39]
    v_mfma_f32_16x16x32_bf16 v[36:39], a[128:131], v[176:179], v[36:39]
    v_mfma_f32_16x16x32_bf16 v[40:43], a[128:131], v[192:195], 0
    v_mfma_f32_16x16x32_bf16 v[40:43], a[132:135], v[196:199], v[40:43]
    v_mfma_f32_16x16x32_bf16 v[40:43], a[136:139], v[200:203], v[40:43]
    v_mfma_f32_16x16x32_bf16 v[40:43], a[140:143], v[204:207], v[40:43]
    v_max3_f32 v153, v32, v33, v34
    v_max_f32 v153, v153, v35
    s_nop 1
    v_max3_f32 v154, v36, v37, v38
    v_max_f32 v154, v154, v39
    s_nop 1
    v_max3_f32 v155, v40, v41, v42
    v_max_f32 v155, v155, v43
    v_mov_b32 v28, v153
    v_mov_b32 v29, v154
    v_mov_b32 v30, v155
    v_permlane32_swap_b32 v153, v28
    v_permlane32_swap_b32 v154, v29
    v_permlane32_swap_b32 v155, v30
    v_max_f32 v153, v153, v28
    v_max_f32 v154, v154, v29
    v_max_f32 v155, v155, v30
    v_mov_b32 v28, v153
    v_mov_b32 v29, v154
    v_mov_b32 v30, v155
    v_permlane16_swap_b32 v153, v28
    v_permlane16_swap_b32 v154, v29
    v_permlane16_swap_b32 v155, v30
    v_max_f32 v153, v153, v28
    v_max_f32 v154, v154, v29
    v_max_f32 v155, v155, v30
    v_sub_f32 v128, 0, v153
    v_sub_f32 v129, 0, v153
    v_sub_f32 v130, 0, v153
    v_sub_f32 v131, 0, v153
    v_sub_f32 v132, 0, v154
    v_sub_f32 v133, 0, v154
    v_sub_f32 v134, 0, v154
    v_sub_f32 v135, 0, v154
    v_sub_f32 v136, 0, v155
    v_sub_f32 v137, 0, v155
    v_sub_f32 v138, 0, v155
    v_sub_f32 v139, 0, v155
    v_sub_f32 v32, v32, v153
    v_sub_f32 v33, v33, v153
    v_sub_f32 v34, v34, v153
    v_sub_f32 v35, v35, v153
    v_sub_f32 v36, v36, v154
    v_sub_f32 v37, v37, v154
    v_sub_f32 v38, v38, v154
    v_sub_f32 v39, v39, v154
    v_sub_f32 v40, v40, v155
    v_sub_f32 v41, v41, v155
    v_sub_f32 v42, v42, v155
    v_sub_f32 v43, v43, v155
    s_cmp_ge_u32 s41, 2
    s_cbranch_scc1 L_ql3
    s_waitcnt vmcnt(8)
    s_branch L_qj3
L_ql3:
    s_waitcnt vmcnt(0)
L_qj3:
    v_lshlrev_b32 v20, 16, v208
    v_and_b32 v21, s46, v208
    v_lshlrev_b32 v22, 16, v209
    v_and_b32 v23, s46, v209
    v_lshlrev_b32 v24, 16, v210
    v_and_b32 v25, s46, v210
    v_lshlrev_b32 v26, 16, v211
    v_and_b32 v27, s46, v211
    v_pk_mul_f32 v[20:21], v[20:21], s[34:35]
    v_pk_mul_f32 v[22:23], v[22:23], s[34:35]
    v_pk_mul_f32 v[24:25], v[24:25], s[34:35]
    v_pk_mul_f32 v[26:27], v[26:27], s[34:35]
    v_cvt_pk_bf16_f32 v208, v20, v21
    v_cvt_pk_bf16_f32 v209, v22, v23
    v_cvt_pk_bf16_f32 v210, v24, v25
    v_cvt_pk_bf16_f32 v211, v26, v27
    v_lshlrev_b32 v20, 16, v212
    v_and_b32 v21, s46, v212
    v_lshlrev_b32 v22, 16, v213
    v_and_b32 v23, s46, v213
    v_lshlrev_b32 v24, 16, v214
    v_and_b32 v25, s46, v214
    v_lshlrev_b32 v26, 16, v215
    v_and_b32 v27, s46, v215
    v_pk_mul_f32 v[20:21], v[20:21], s[34:35]
    v_pk_mul_f32 v[22:23], v[22:23], s[34:35]
    v_pk_mul_f32 v[24:25], v[24:25], s[34:35]
    v_pk_mul_f32 v[26:27], v[26:27], s[34:35]
    v_cvt_pk_bf16_f32 v212, v20, v21
    v_cvt_pk_bf16_f32 v213, v22, v23
    v_cvt_pk_bf16_f32 v214, v24, v25
    v_cvt_pk_bf16_f32 v215, v26, v27
    v_lshlrev_b32 v20, 16, v216
    v_and_b32 v21, s46, v216
    v_lshlrev_b32 v22, 16, v217
    v_and_b32 v23, s46, v217
    v_lshlrev_b32 v24, 16, v218
    v_and_b32 v25, s46, v218
    v_lshlrev_b32 v26, 16, v219
    v_and_b32 v27, s46, v219
    v_pk_mul_f32 v[20:21], v[20:21], s[34:35]
    v_pk_mul_f32 v[22:23], v[22:23], s[34:35]
    v_pk_mul_f32 v[24:25], v[24:25], s[34:35]
    v_pk_mul_f32 v[26:27], v[26:27], s[34:35]
    v_cvt_pk_bf16_f32 v216, v20, v21
    v_cvt_pk_bf16_f32 v217, v22, v23
    v_cvt_pk_bf16_f32 v218, v24, v25
    v_cvt_pk_bf16_f32 v219, v26, v27
    v_lshlrev_b32 v20, 16, v220
    v_and_b32 v21, s46, v220
    v_lshlrev_b32 v22, 16, v221
    v_and_b32 v23, s46, v221
    v_lshlrev_b32 v24, 16, v222
    v_and_b32 v25, s46, v222
    v_lshlrev_b32 v26, 16, v223
    v_and_b32 v27, s46, v223
    v_pk_mul_f32 v[20:21], v[20:21], s[34:35]
    v_pk_mul_f32 v[22:23], v[22:23], s[34:35]
    v_pk_mul_f32 v[24:25], v[24:25], s[34:35]
    v_pk_mul_f32 v[26:27], v[26:27], s[34:35]
    v_cvt_pk_bf16_f32 v220, v20, v21
    v_cvt_pk_bf16_f32 v221, v22, v23
    v_cvt_pk_bf16_f32 v222, v24, v25
    v_cvt_pk_bf16_f32 v223, v26, v27
    s_nop 1
    v_mfma_f32_16x16x32_bf16 v[44:47], a[140:143], v[220:223], 0
    v_mfma_f32_16x16x32_bf16 v[44:47], a[136:139], v[216:219], v[44:47]
    v_mfma_f32_16x16x32_bf16 v[44:47], a[132:135], v[212:215], v[44:47]
    v_mfma_f32_16x16x32_bf16 v[44:47], a[128:131], v[208:211], v[44:47]
    s_lshl_b32 s42, s33, 14
    s_sub_u32 s42, 0x8000, s42
    s_cmp_ge_u32 s41, 3
    s_cselect_b32 s42, s18, s42
    s_cselect_b32 m0, s43, s52
    s_nop 0
    buffer_load_dwordx4 v13, s[16:19], s42 offen offset:0 nt lds
    buffer_load_dwordx4 v14, s[16:19], s42 offen offset:1024 nt lds
    buffer_load_dwordx4 v15, s[16:19], s42 offen offset:2048 nt lds
    buffer_load_dwordx4 v16, s[16:19], s42 offen offset:3072 nt lds
    s_lshl_b32 s29, s33, 14
    s_sub_u32 s29, 0xe000, s29
    v_max3_f32 v156, v44, v45, v46
    v_max_f32 v156, v156, v47
    v_mov_b32 v28, v156
    s_nop 1
    v_permlane32_swap_b32 v156, v28
    v_max_f32 v156, v156, v28
    v_mov_b32 v28, v156
    s_nop 1
    v_permlane16_swap_b32 v156, v28
    v_max_f32 v156, v156, v28
    v_sub_f32 v140, 0, v156
    v_sub_f32 v141, 0, v156
    v_sub_f32 v142, 0, v156
    v_sub_f32 v143, 0, v156
    v_sub_f32 v44, v44, v156
    v_sub_f32 v45, v45, v156
    v_sub_f32 v46, v46, v156
    v_sub_f32 v47, v47, v156
    s_lshl_b32 s42, s33, 14
    s_sub_u32 s42, 0xa000, s42
    s_cmp_ge_u32 s41, 4
    s_cselect_b32 s42, s18, s42
    s_cselect_b32 m0, s43, s53
    s_nop 0
    buffer_load_dwordx4 v13, s[16:19], s42 offen offset:0 nt lds
    buffer_load_dwordx4 v14, s[16:19], s42 offen offset:1024 nt lds
    buffer_load_dwordx4 v15, s[16:19], s42 offen offset:2048 nt lds
    buffer_load_dwordx4 v16, s[16:19], s42 offen offset:3072 nt lds
    v_exp_f32 v32, v32
    ds_read_b128 a[128:131], v1 offset:4096
    v_exp_f32 v33, v33
    ds_read_b128 a[132:135], v2 offset:4096
    v_cvt_pk_bf16_f32 v64, v32, v33
    v_exp_f32 v34, v34
    ds_read_b128 a[136:139], v3 offset:4096
    v_exp_f32 v35, v35
    ds_read_b128 a[140:143], v4 offset:4096
    v_cvt_pk_bf16_f32 v65, v34, v35
    v_exp_f32 v36, v36
    v_exp_f32 v37, v37
    s_nop 0
    v_cvt_pk_bf16_f32 v72, v36, v37
    v_exp_f32 v38, v38
    v_exp_f32 v39, v39
    s_nop 0
    v_cvt_pk_bf16_f32 v73, v38, v39
    s_waitcnt lgkmcnt(0)
    v_mfma_f32_16x16x32_bf16 v[48:51], a[128:131], v[160:163], v[128:131]
    s_lshl_b32 s42, s33, 14
    s_sub_u32 s42, 0xc000, s42
    s_cmp_ge_u32 s41, 5
    s_cselect_b32 s42, s18, s42
    s_cselect_b32 m0, s43, s54
    v_mfma_f32_16x16x32_bf16 v[48:51], a[132:135], v[164:167], v[48:51]
    v_exp_f32 v40, v40
    v_mfma_f32_16x16x32_bf16 v[48:51], a[136:139], v[168:171], v[48:51]
    buffer_load_dwordx4 v13, s[16:19], s42 offen offset:0 nt lds
    v_mfma_f32_16x16x32_bf16 v[48:51], a[140:143], v[172:175], v[48:51]
    v_exp_f32 v41, v41
    v_mfma_f32_16x16x32_bf16 v[52:55], a[140:143], v[188:191], v[132:135]
    buffer_load_dwordx4 v14, s[16:19], s42 offen offset:1024 nt lds
    v_mfma_f32_16x16x32_bf16 v[52:55], a[136:139], v[184:187], v[52:55]
    v_exp_f32 v42, v42
    v_mfma_f32_16x16x32_bf16 v[52:55], a[132:135], v[180:183], v[52:55]
    buffer_load_dwordx4 v15, s[16:19], s42 offen offset:2048 nt lds
    v_mfma_f32_16x16x32_bf16 v[52:55], a[128:131], v[176:179], v[52:55]
    v_exp_f32 v43, v43
    v_mfma_f32_16x16x32_bf16 v[56:59], a[128:131], v[192:195], v[136:139]
    buffer_load_dwordx4 v16, s[16:19], s42 offen offset:3072 nt lds
    v_cvt_pk_bf16_f32 v80, v40, v41
    v_cvt_pk_bf16_f32 v81, v42, v43
    v_mfma_f32_16x16x32_bf16 v[56:59], a[132:135], v[196:199], v[56:59]
    v_exp_f32 v44, v44
    v_mfma_f32_16x16x32_bf16 v[56:59], a[136:139], v[200:203], v[56:59]
    v_mfma_f32_16x16x32_bf16 v[56:59], a[140:143], v[204:207], v[56:59]
    v_exp_f32 v45, v45
    v_mfma_f32_16x16x32_bf16 v[60:63], a[140:143], v[220:223], v[140:143]
    v_cvt_pk_bf16_f32 v88, v44, v45
    v_mfma_f32_16x16x32_bf16 v[60:63], a[136:139], v[216:219], v[60:63]
    v_exp_f32 v46, v46
    v_mfma_f32_16x16x32_bf16 v[60:63], a[132:135], v[212:215], v[60:63]
    v_mfma_f32_16x16x32_bf16 v[60:63], a[128:131], v[208:211], v[60:63]
    v_exp_f32 v47, v47
    s_nop 0
    v_cvt_pk_bf16_f32 v89, v46, v47
    v_exp_f32 v48, v48
    ds_read_b128 a[128:131], v1 offset:8192
    v_exp_f32 v49, v49
    ds_read_b128 a[132:135], v2 offset:8192
    v_cvt_pk_bf16_f32 v66, v48, v49
    v_exp_f32 v50, v50
    ds_read_b128 a[136:139], v3 offset:8192
    v_exp_f32 v51, v51
    ds_read_b128 a[140:143], v4 offset:8192
    v_cvt_pk_bf16_f32 v67, v50, v51
    v_exp_f32 v52, v52
    v_exp_f32 v53, v53
    s_nop 0
    v_cvt_pk_bf16_f32 v74, v52, v53
    v_exp_f32 v54, v54
    v_exp_f32 v55, v55
    s_nop 0
    v_cvt_pk_bf16_f32 v75, v54, v55
    s_waitcnt lgkmcnt(0)
    v_mfma_f32_16x16x32_bf16 v[32:35], a[128:131], v[160:163], v[128:131]
    s_lshl_b32 s42, s33, 14
    s_sub_u32 s42, 0xe000, s42
    s_cmp_ge_u32 s41, 6
    s_cselect_b32 s42, s18, s42
    s_cselect_b32 m0, s43, s55
    v_mfma_f32_16x16x32_bf16 v[32:35], a[132:135], v[164:167], v[32:35]
    v_exp_f32 v56, v56
    v_mfma_f32_16x16x32_bf16 v[32:35], a[136:139], v[168:171], v[32:35]
    buffer_load_dwordx4 v13, s[16:19], s42 offen offset:0 nt lds
    v_mfma_f32_16x16x32_bf16 v[32:35], a[140:143], v[172:175], v[32:35]
    v_exp_f32 v57, v57
    v_mfma_f32_16x16x32_bf16 v[36:39], a[140:143], v[188:191], v[132:135]
    buffer_load_dwordx4 v14, s[16:19], s42 offen offset:1024 nt lds
    v_mfma_f32_16x16x32_bf16 v[36:39], a[136:139], v[184:187], v[36:39]
    v_exp_f32 v58, v58
    v_mfma_f32_16x16x32_bf16 v[36:39], a[132:135], v[180:183], v[36:39]
    buffer_load_dwordx4 v15, s[16:19], s42 offen offset:2048 nt lds
    v_mfma_f32_16x16x32_bf16 v[36:39], a[128:131], v[176:179], v[36:39]
    v_exp_f32 v59, v59
    v_mfma_f32_16x16x32_bf16 v[40:43], a[128:131], v[192:195], v[136:139]
    buffer_load_dwordx4 v16, s[16:19], s42 offen offset:3072 nt lds
    v_cvt_pk_bf16_f32 v82, v56, v57
    v_cvt_pk_bf16_f32 v83, v58, v59
    v_mfma_f32_16x16x32_bf16 v[40:43], a[132:135], v[196:199], v[40:43]
    v_exp_f32 v60, v60
    v_mfma_f32_16x16x32_bf16 v[40:43], a[136:139], v[200:203], v[40:43]
    v_mfma_f32_16x16x32_bf16 v[40:43], a[140:143], v[204:207], v[40:43]
    v_exp_f32 v61, v61
    v_mfma_f32_16x16x32_bf16 v[44:47], a[140:143], v[220:223], v[140:143]
    v_cvt_pk_bf16_f32 v90, v60, v61
    v_mfma_f32_16x16x32_bf16 v[44:47], a[136:139], v[216:219], v[44:47]
    v_exp_f32 v62, v62
    v_mfma_f32_16x16x32_bf16 v[44:47], a[132:135], v[212:215], v[44:47]
    v_mfma_f32_16x16x32_bf16 v[44:47], a[128:131], v[208:211], v[44:47]
    v_exp_f32 v63, v63
    s_nop 0
    v_cvt_pk_bf16_f32 v91, v62, v63
    v_exp_f32 v32, v32
    ds_read_b128 a[128:131], v1 offset:12288
    v_exp_f32 v33, v33
    ds_read_b128 a[132:135], v2 offset:12288
    v_cvt_pk_bf16_f32 v68, v32, v33
    v_exp_f32 v34, v34
    ds_read_b128 a[136:139], v3 offset:12288
    v_exp_f32 v35, v35
    ds_read_b128 a[140:143], v4 offset:12288
    v_cvt_pk_bf16_f32 v69, v34, v35
    v_exp_f32 v36, v36
    v_exp_f32 v37, v37
    s_nop 0
    v_cvt_pk_bf16_f32 v76, v36, v37
    v_exp_f32 v38, v38
    v_exp_f32 v39, v39
    s_nop 0
    v_cvt_pk_bf16_f32 v77, v38, v39
    s_waitcnt lgkmcnt(0)
    v_mfma_f32_16x16x32_bf16 v[48:51], a[128:131], v[160:163], v[128:131]
    v_mfma_f32_16x16x32_bf16 v[48:51], a[132:135], v[164:167], v[48:51]
    v_exp_f32 v40, v40
    v_mfma_f32_16x16x32_bf16 v[48:51], a[136:139], v[168:171], v[48:51]
    v_mfma_f32_16x16x32_bf16 v[48:51], a[140:143], v[172:175], v[48:51]
    v_exp_f32 v41, v41
    v_mfma_f32_16x16x32_bf16 v[52:55], a[140:143], v[188:191], v[132:135]
    v_mfma_f32_16x16x32_bf16 v[52:55], a[136:139], v[184:187], v[52:55]
    v_exp_f32 v42, v42
    v_mfma_f32_16x16x32_bf16 v[52:55], a[132:135], v[180:183], v[52:55]
    v_mfma_f32_16x16x32_bf16 v[52:55], a[128:131], v[176:179], v[52:55]
    v_exp_f32 v43, v43
    v_mfma_f32_16x16x32_bf16 v[56:59], a[128:131], v[192:195], v[136:139]
    v_cvt_pk_bf16_f32 v84, v40, v41
    v_cvt_pk_bf16_f32 v85, v42, v43
    v_mfma_f32_16x16x32_bf16 v[56:59], a[132:135], v[196:199], v[56:59]
    v_exp_f32 v44, v44
    v_mfma_f32_16x16x32_bf16 v[56:59], a[136:139], v[200:203], v[56:59]
    v_mfma_f32_16x16x32_bf16 v[56:59], a[140:143], v[204:207], v[56:59]
    v_exp_f32 v45, v45
    v_mfma_f32_16x16x32_bf16 v[60:63], a[140:143], v[220:223], v[140:143]
    v_cvt_pk_bf16_f32 v92, v44, v45
    v_mfma_f32_16x16x32_bf16 v[60:63], a[136:139], v[216:219], v[60:63]
    v_exp_f32 v46, v46
    v_mfma_f32_16x16x32_bf16 v[60:63], a[132:135], v[212:215], v[60:63]
    v_mfma_f32_16x16x32_bf16 v[60:63], a[128:131], v[208:211], v[60:63]
    v_exp_f32 v47, v47
    s_nop 0
    v_cvt_pk_bf16_f32 v93, v46, v47
    s_waitcnt vmcnt(16) lgkmcnt(0)
    v_exp_f32 v48, v48
    s_barrier
    ds_read_b128 a[128:131], v1 offset:16384
    v_exp_f32 v49, v49
    ds_read_b128 a[132:135], v2 offset:16384
    v_cvt_pk_bf16_f32 v70, v48, v49
    v_exp_f32 v50, v50
    ds_read_b128 a[136:139], v3 offset:16384
    s_mov_b32 m0, s48
    v_exp_f32 v51, v51
    ds_read_b128 a[140:143], v4 offset:16384
    v_cvt_pk_bf16_f32 v71, v50, v51
    s_add_u32 s29, s29, 0x2000
    v_exp_f32 v52, v52
    buffer_load_dwordx4 v13, s[16:19], s29 offen offset:0 nt lds
    v_exp_f32 v53, v53
    s_nop 0
    v_cvt_pk_bf16_f32 v78, v52, v53
    v_exp_f32 v54, v54
    buffer_load_dwordx4 v14, s[16:19], s29 offen offset:1024 nt lds
    v_exp_f32 v55, v55
    s_nop 0
    v_cvt_pk_bf16_f32 v79, v54, v55
    s_waitcnt lgkmcnt(0)
    s_movk_i32 s31, 8
    s_branch L_ep1B
.p2align 6
L_loopB:
    v_mfma_f32_16x16x32_bf16 v[32:35], a[128:131], v[160:163], v[128:131]
    ds_read_b64_tr_b16 a[144:145], v5 offset:49152
    ds_read_b64_tr_b16 a[146:147], v5 offset:53248
    v_mfma_f32_16x16x32_bf16 v[32:35], a[132:135], v[164:167], v[32:35]
    v_exp_f32 v56, v56
    v_mfma_f32_16x16x32_bf16 v[32:35], a[136:139], v[168:171], v[32:35]
    ds_read_b64_tr_b16 a[148:149], v5 offset:57344
    ds_read_b64_tr_b16 a[150:151], v5 offset:61440
    v_mfma_f32_16x16x32_bf16 v[32:35], a[140:143], v[172:175], v[32:35]
    v_exp_f32 v57, v57
    v_mfma_f32_16x16x32_bf16 v[36:39], a[140:143], v[188:191], v[132:135]
    ds_read_b64_tr_b16 a[152:153], v6 offset:49152
    ds_read_b64_tr_b16 a[154:155], v6 offset:53248
    v_mfma_f32_16x16x32_bf16 v[36:39], a[136:139], v[184:187], v[36:39]
    v_exp_f32 v58, v58
    v_mfma_f32_16x16x32_bf16 v[36:39], a[132:135], v[180:183], v[36:39]
    ds_read_b64_tr_b16 a[156:157], v6 offset:57344
    ds_read_b64_tr_b16 a[158:159], v6 offset:61440
    v_mfma_f32_16x16x32_bf16 v[36:39], a[128:131], v[176:179], v[36:39]
    v_exp_f32 v59, v59
    v_mfma_f32_16x16x32_bf16 v[40:43], a[128:131], v[192:195], v[136:139]
    v_cvt_pk_bf16_f32 v118, v56, v57
    v_cvt_pk_bf16_f32 v119, v58, v59
    v_mfma_f32_16x16x32_bf16 v[40:43], a[132:135], v[196:199], v[40:43]
    v_exp_f32 v60, v60
    v_mfma_f32_16x16x32_bf16 v[40:43], a[136:139], v[200:203], v[40:43]
    v_mfma_f32_16x16x32_bf16 v[40:43], a[140:143], v[204:207], v[40:43]
    v_exp_f32 v61, v61
    v_mfma_f32_16x16x32_bf16 v[44:47], a[140:143], v[220:223], v[140:143]
    v_cvt_pk_bf16_f32 v126, v60, v61
    v_mfma_f32_16x16x32_bf16 v[44:47], a[136:139], v[216:219], v[44:47]
    v_exp_f32 v62, v62
    v_mfma_f32_16x16x32_bf16 v[44:47], a[132:135], v[212:215], v[44:47]
    v_mfma_f32_16x16x32_bf16 v[44:47], a[128:131], v[208:211], v[44:47]
    v_exp_f32 v63, v63
    v_mfma_f32_16x16x32_bf16 v[144:147], v[96:99], a[160:163], v[144:147]
    v_cvt_pk_bf16_f32 v127, v62, v63
    v_mfma_f32_16x16x32_bf16 v[144:147], v[100:103], a[160:163], v[144:147]
    s_waitcnt lgkmcnt(0)
    v_exp_f32 v32, v32
    v_mfma_f32_16x16x32_bf16 a[0:3], v[96:99], a[144:147], a[0:3]
    v_mfma_f32_16x16x32_bf16 a[0:3], v[100:103], a[148:151], a[0:3]
    v_exp_f32 v33, v33
    ds_read_b128 a[128:131], v1 offset:4096
    v_mfma_f32_16x16x32_bf16 a[4:7], v[108:111], a[148:151], a[4:7]
    v_cvt_pk_bf16_f32 v64, v32, v33
    v_mfma_f32_16x16x32_bf16 a[4:7], v[104:107], a[144:147], a[4:7]
    v_exp_f32 v34, v34
    ds_read_b128 a[132:135], v2 offset:4096
    v_mfma_f32_16x16x32_bf16 a[8:11], v[112:115], a[144:147], a[8:11]
    v_mfma_f32_16x16x32_bf16 a[8:11], v[116:119], a[148:151], a[8:11]
    v_exp_f32 v35, v35
    ds_read_b128 a[136:139], v3 offset:4096
    v_mfma_f32_16x16x32_bf16 a[12:15], v[124:127], a[148:151], a[12:15]
    v_cvt_pk_bf16_f32 v65, v34, v35
    v_mfma_f32_16x16x32_bf16 a[12:15], v[120:123], a[144:147], a[12:15]
    v_exp_f32 v36, v36
    ds_read_b128 a[140:143], v4 offset:4096
    v_mfma_f32_16x16x32_bf16 a[16:19], v[96:99], a[152:155], a[16:19]
    buffer_load_dwordx4 v15, s[16:19], s29 offen offset:2048 nt lds
    v_mfma_f32_16x16x32_bf16 a[16:19], v[100:103], a[156:159], a[16:19]
    v_exp_f32 v37, v37
    v_mfma_f32_16x16x32_bf16 a[20:23], v[108:111], a[156:159], a[20:23]
    v_cvt_pk_bf16_f32 v72, v36, v37
    v_mfma_f32_16x16x32_bf16 a[20:23], v[104:107], a[152:155], a[20:23]
    v_exp_f32 v38, v38
    v_mfma_f32_16x16x32_bf16 a[24:27], v[112:115], a[152:155], a[24:27]
    buffer_load_dwordx4 v16, s[16:19], s29 offen offset:3072 nt lds
    v_mfma_f32_16x16x32_bf16 a[24:27], v[116:119], a[156:159], a[24:27]
    v_exp_f32 v39, v39
    v_mfma_f32_16x16x32_bf16 a[28:31], v[124:127], a[156:159], a[28:31]
    v_cvt_pk_bf16_f32 v73, v38, v39
    v_mfma_f32_16x16x32_bf16 a[28:31], v[120:123], a[152:155], a[28:31]
    s_waitcnt lgkmcnt(0)
    v_mfma_f32_16x16x32_bf16 v[48:51], a[128:131], v[160:163], v[128:131]
    ds_read_b64_tr_b16 a[144:145], v7 offset:49152
    ds_read_b64_tr_b16 a[146:147], v7 offset:53248
    v_mfma_f32_16x16x32_bf16 v[48:51], a[132:135], v[164:167], v[48:51]
    v_exp_f32 v40, v40
    v_mfma_f32_16x16x32_bf16 v[48:51], a[136:139], v[168:171], v[48:51]
    ds_read_b64_tr_b16 a[148:149], v7 offset:57344
    ds_read_b64_tr_b16 a[150:151], v7 offset:61440
    v_mfma_f32_16x16x32_bf16 v[48:51], a[140:143], v[172:175], v[48:51]
    v_exp_f32 v41, v41
    v_mfma_f32_16x16x32_bf16 v[52:55], a[140:143], v[188:191], v[132:135]
    ds_read_b64_tr_b16 a[152:153], v8 offset:49152
    ds_read_b64_tr_b16 a[154:155], v8 offset:53248
    v_mfma_f32_16x16x32_bf16 v[52:55], a[136:139], v[184:187], v[52:55]
    v_exp_f32 v42, v42
    v_mfma_f32_16x16x32_bf16 v[52:55], a[132:135], v[180:183], v[52:55]
    ds_read_b64_tr_b16 a[156:157], v8 offset:57344
    ds_read_b64_tr_b16 a[158:159], v8 offset:61440
    v_mfma_f32_16x16x32_bf16 v[52:55], a[128:131], v[176:179], v[52:55]
    v_exp_f32 v43, v43
    v_mfma_f32_16x16x32_bf16 v[56:59], a[128:131], v[192:195], v[136:139]
    v_cvt_pk_bf16_f32 v80, v40, v41
    v_cvt_pk_bf16_f32 v81, v42, v43
    v_mfma_f32_16x16x32_bf16 v[56:59], a[132:135], v[196:199], v[56:59]
    v_exp_f32 v44, v44
    v_mfma_f32_16x16x32_bf16 v[56:59], a[136:139], v[200:203], v[56:59]
    v_mfma_f32_16x16x32_bf16 v[56:59], a[140:143], v[204:207], v[56:59]
    v_exp_f32 v45, v45
    v_mfma_f32_16x16x32_bf16 v[60:63], a[140:143], v[220:223], v[140:143]
    v_cvt_pk_bf16_f32 v88, v44, v45
    v_mfma_f32_16x16x32_bf16 v[60:63], a[136:139], v[216:219], v[60:63]
    v_exp_f32 v46, v46
    v_mfma_f32_16x16x32_bf16 v[60:63], a[132:135], v[212:215], v[60:63]
    v_mfma_f32_16x16x32_bf16 v[60:63], a[128:131], v[208:211], v[60:63]
    v_exp_f32 v47, v47
    v_mfma_f32_16x16x32_bf16 v[144:147], v[104:107], a[164:167], v[144:147]
    v_cvt_pk_bf16_f32 v89, v46, v47
    v_mfma_f32_16x16x32_bf16 v[144:147], v[108:111], a[164:167], v[144:147]
    s_waitcnt lgkmcnt(0)
    v_exp_f32 v48, v48
    v_mfma_f32_16x16x32_bf16 a[32:35], v[96:99], a[144:147], a[32:35]
    v_mfma_f32_16x16x32_bf16 a[32:35], v[100:103], a[148:151], a[32:35]
    v_exp_f32 v49, v49
    ds_read_b128 a[128:131], v1 offset:8192
    v_mfma_f32_16x16x32_bf16 a[36:39], v[108:111], a[148:151], a[36:39]
    v_cvt_pk_bf16_f32 v66, v48, v49
    v_mfma_f32_16x16x32_bf16 a[36:39], v[104:107], a[144:147], a[36:39]
    v_exp_f32 v50, v50
    ds_read_b128 a[132:135], v2 offset:8192
    v_mfma_f32_16x16x32_bf16 a[40:43], v[112:115], a[144:147], a[40:43]
    v_mfma_f32_16x16x32_bf16 a[40:43], v[116:119], a[148:151], a[40:43]
    s_mov_b32 m0, s55
    v_exp_f32 v51, v51
    ds_read_b128 a[136:139], v3 offset:8192
    v_mfma_f32_16x16x32_bf16 a[44:47], v[124:127], a[148:151], a[44:47]
    v_cvt_pk_bf16_f32 v67, v50, v51
    v_mfma_f32_16x16x32_bf16 a[44:47], v[120:123], a[144:147], a[44:47]
    s_add_u32 s29, s29, 0x2000
    v_exp_f32 v52, v52
    ds_read_b128 a[140:143], v4 offset:8192
    v_mfma_f32_16x16x32_bf16 a[48:51], v[96:99], a[152:155], a[48:51]
    buffer_load_dwordx4 v13, s[16:19], s29 offen offset:0 nt lds
    v_mfma_f32_16x16x32_bf16 a[48:51], v[100:103], a[156:159], a[48:51]
    v_exp_f32 v53, v53
    v_mfma_f32_16x16x32_bf16 a[52:55], v[108:111], a[156:159], a[52:55]
    v_cvt_pk_bf16_f32 v74, v52, v53
    v_mfma_f32_16x16x32_bf16 a[52:55], v[104:107], a[152:155], a[52:55]
    v_exp_f32 v54, v54
    v_mfma_f32_16x16x32_bf16 a[56:59], v[112:115], a[152:155], a[56:59]
    buffer_load_dwordx4 v14, s[16:19], s29 offen offset:1024 nt lds
    v_mfma_f32_16x16x32_bf16 a[56:59], v[116:119], a[156:159], a[56:59]
    v_exp_f32 v55, v55
    v_mfma_f32_16x16x32_bf16 a[60:63], v[124:127], a[156:159], a[60:63]
    v_cvt_pk_bf16_f32 v75, v54, v55
    v_mfma_f32_16x16x32_bf16 a[60:63], v[120:123], a[152:155], a[60:63]
    s_waitcnt lgkmcnt(0)
    v_mfma_f32_16x16x32_bf16 v[32:35], a[128:131], v[160:163], v[128:131]
    ds_read_b64_tr_b16 a[144:145], v9 offset:49152
    ds_read_b64_tr_b16 a[146:147], v9 offset:53248
    v_mfma_f32_16x16x32_bf16 v[32:35], a[132:135], v[164:167], v[32:35]
    v_exp_f32 v56, v56
    v_mfma_f32_16x16x32_bf16 v[32:35], a[136:139], v[168:171], v[32:35]
    ds_read_b64_tr_b16 a[148:149], v9 offset:57344
    ds_read_b64_tr_b16 a[150:151], v9 offset:61440
    v_mfma_f32_16x16x32_bf16 v[32:35], a[140:143], v[172:175], v[32:35]
    v_exp_f32 v57, v57
    v_mfma_f32_16x16x32_bf16 v[36:39], a[140:143], v[188:191], v[132:135]
    ds_read_b64_tr_b16 a[152:153], v10 offset:49152
    ds_read_b64_tr_b16 a[154:155], v10 offset:53248
    v_mfma_f32_16x16x32_bf16 v[36:39], a[136:139], v[184:187], v[36:39]
    v_exp_f32 v58, v58
    v_mfma_f32_16x16x32_bf16 v[36:39], a[132:135], v[180:183], v[36:39]
    ds_read_b64_tr_b16 a[156:157], v10 offset:57344
    ds_read_b64_tr_b16 a[158:159], v10 offset:61440
    v_mfma_f32_16x16x32_bf16 v[36:39], a[128:131], v[176:179], v[36:39]
    v_exp_f32 v59, v59
    v_mfma_f32_16x16x32_bf16 v[40:43], a[128:131], v[192:195], v[136:139]
    v_cvt_pk_bf16_f32 v82, v56, v57
    v_cvt_pk_bf16_f32 v83, v58, v59
    v_mfma_f32_16x16x32_bf16 v[40:43], a[132:135], v[196:199], v[40:43]
    v_exp_f32 v60, v60
    v_mfma_f32_16x16x32_bf16 v[40:43], a[136:139], v[200:203], v[40:43]
    v_mfma_f32_16x16x32_bf16 v[40:43], a[140:143], v[204:207], v[40:43]
    v_exp_f32 v61, v61
    v_mfma_f32_16x16x32_bf16 v[44:47], a[140:143], v[220:223], v[140:143]
    v_cvt_pk_bf16_f32 v90, v60, v61
    v_mfma_f32_16x16x32_bf16 v[44:47], a[136:139], v[216:219], v[44:47]
    v_exp_f32 v62, v62
    v_mfma_f32_16x16x32_bf16 v[44:47], a[132:135], v[212:215], v[44:47]
    v_mfma_f32_16x16x32_bf16 v[44:47], a[128:131], v[208:211], v[44:47]
    v_exp_f32 v63, v63
    v_mfma_f32_16x16x32_bf16 v[144:147], v[112:115], a[168:171], v[144:147]
    v_cvt_pk_bf16_f32 v91, v62, v63
    v_mfma_f32_16x16x32_bf16 v[144:147], v[116:119], a[168:171], v[144:147]
    s_waitcnt lgkmcnt(0)
    v_exp_f32 v32, v32
    v_mfma_f32_16x16x32_bf16 a[64:67], v[96:99], a[144:147], a[64:67]
    v_mfma_f32_16x16x32_bf16 a[64:67], v[100:103], a[148:151], a[64:67]
    v_exp_f32 v33, v33
    ds_read_b128 a[128:131], v1 offset:12288
    v_mfma_f32_16x16x32_bf16 a[68:71], v[108:111], a[148:151], a[68:71]
    v_cvt_pk_bf16_f32 v68, v32, v33
    v_mfma_f32_16x16x32_bf16 a[68:71], v[104:107], a[144:147], a[68:71]
    v_exp_f32 v34, v34
    ds_read_b128 a[132:135], v2 offset:12288
    v_mfma_f32_16x16x32_bf16 a[72:75], v[112:115], a[144:147], a[72:75]
    v_mfma_f32_16x16x32_bf16 a[72:75], v[116:119], a[148:151], a[72:75]
    v_exp_f32 v35, v35
    ds_read_b128 a[136:139], v3 offset:12288
    v_mfma_f32_16x16x32_bf16 a[76:79], v[124:127], a[148:151], a[76:79]
    v_cvt_pk_bf16_f32 v69, v34, v35
    v_mfma_f32_16x16x32_bf16 a[76:79], v[120:123], a[144:147], a[76:79]
    v_exp_f32 v36, v36
    ds_read_b128 a[140:143], v4 offset:12288
    v_mfma_f32_16x16x32_bf16 a[80:83], v[96:99], a[152:155], a[80:83]
    buffer_load_dwordx4 v15, s[16:19], s29 offen offset:2048 nt lds
    v_mfma_f32_16x16x32_bf16 a[80:83], v[100:103], a[156:159], a[80:83]
    v_exp_f32 v37, v37
    v_mfma_f32_16x16x32_bf16 a[84:87], v[108:111], a[156:159], a[84:87]
    v_cvt_pk_bf16_f32 v76, v36, v37
    v_mfma_f32_16x16x32_bf16 a[84:87], v[104:107], a[152:155], a[84:87]
    v_exp_f32 v38, v38
    v_mfma_f32_16x16x32_bf16 a[88:91], v[112:115], a[152:155], a[88:91]
    buffer_load_dwordx4 v16, s[16:19], s29 offen offset:3072 nt lds
    v_mfma_f32_16x16x32_bf16 a[88:91], v[116:119], a[156:159], a[88:91]
    v_exp_f32 v39, v39
    v_mfma_f32_16x16x32_bf16 a[92:95], v[124:127], a[156:159], a[92:95]
    v_cvt_pk_bf16_f32 v77, v38, v39
    v_mfma_f32_16x16x32_bf16 a[92:95], v[120:123], a[152:155], a[92:95]
    s_waitcnt lgkmcnt(0)
    v_mfma_f32_16x16x32_bf16 v[48:51], a[128:131], v[160:163], v[128:131]
    ds_read_b64_tr_b16 a[144:145], v11 offset:49152
    ds_read_b64_tr_b16 a[146:147], v11 offset:53248
    v_mfma_f32_16x16x32_bf16 v[48:51], a[132:135], v[164:167], v[48:51]
    v_exp_f32 v40, v40
    v_mfma_f32_16x16x32_bf16 v[48:51], a[136:139], v[168:171], v[48:51]
    ds_read_b64_tr_b16 a[148:149], v11 offset:57344
    ds_read_b64_tr_b16 a[150:151], v11 offset:61440
    v_mfma_f32_16x16x32_bf16 v[48:51], a[140:143], v[172:175], v[48:51]
    v_exp_f32 v41, v41
    v_mfma_f32_16x16x32_bf16 v[52:55], a[140:143], v[188:191], v[132:135]
    ds_read_b64_tr_b16 a[152:153], v12 offset:49152
    ds_read_b64_tr_b16 a[154:155], v12 offset:53248
    v_mfma_f32_16x16x32_bf16 v[52:55], a[136:139], v[184:187], v[52:55]
    v_exp_f32 v42, v42
    v_mfma_f32_16x16x32_bf16 v[52:55], a[132:135], v[180:183], v[52:55]
    ds_read_b64_tr_b16 a[156:157], v12 offset:57344
    ds_read_b64_tr_b16 a[158:159], v12 offset:61440
    v_mfma_f32_16x16x32_bf16 v[52:55], a[128:131], v[176:179], v[52:55]
    v_exp_f32 v43, v43
    v_mfma_f32_16x16x32_bf16 v[56:59], a[128:131], v[192:195], v[136:139]
    v_cvt_pk_bf16_f32 v84, v40, v41
    v_cvt_pk_bf16_f32 v85, v42, v43
    v_mfma_f32_16x16x32_bf16 v[56:59], a[132:135], v[196:199], v[56:59]
    v_exp_f32 v44, v44
    v_mfma_f32_16x16x32_bf16 v[56:59], a[136:139], v[200:203], v[56:59]
    v_mfma_f32_16x16x32_bf16 v[56:59], a[140:143], v[204:207], v[56:59]
    v_exp_f32 v45, v45
    v_mfma_f32_16x16x32_bf16 v[60:63], a[140:143], v[220:223], v[140:143]
    v_cvt_pk_bf16_f32 v92, v44, v45
    v_mfma_f32_16x16x32_bf16 v[60:63], a[136:139], v[216:219], v[60:63]
    v_exp_f32 v46, v46
    v_mfma_f32_16x16x32_bf16 v[60:63], a[132:135], v[212:215], v[60:63]
    v_mfma_f32_16x16x32_bf16 v[60:63], a[128:131], v[208:211], v[60:63]
    v_exp_f32 v47, v47
    v_mfma_f32_16x16x32_bf16 v[144:147], v[120:123], a[172:175], v[144:147]
    v_cvt_pk_bf16_f32 v93, v46, v47
    v_mfma_f32_16x16x32_bf16 v[144:147], v[124:127], a[172:175], v[144:147]
    s_waitcnt vmcnt(16) lgkmcnt(0)
    v_exp_f32 v48, v48
    v_mfma_f32_16x16x32_bf16 a[96:99], v[96:99], a[144:147], a[96:99]
    s_barrier
    v_mfma_f32_16x16x32_bf16 a[96:99], v[100:103], a[148:151], a[96:99]
    v_exp_f32 v49, v49
    ds_read_b128 a[128:131], v1 offset:16384
    v_mfma_f32_16x16x32_bf16 a[100:103], v[108:111], a[148:151], a[100:103]
    v_cvt_pk_bf16_f32 v70, v48, v49
    v_mfma_f32_16x16x32_bf16 a[100:103], v[104:107], a[144:147], a[100:103]
    v_exp_f32 v50, v50
    ds_read_b128 a[132:135], v2 offset:16384
    v_mfma_f32_16x16x32_bf16 a[104:107], v[112:115], a[144:147], a[104:107]
    v_mfma_f32_16x16x32_bf16 a[104:107], v[116:119], a[148:151], a[104:107]
    s_mov_b32 m0, s48
    v_exp_f32 v51, v51
    ds_read_b128 a[136:139], v3 offset:16384
    v_mfma_f32_16x16x32_bf16 a[108:111], v[124:127], a[148:151], a[108:111]
    v_cvt_pk_bf16_f32 v71, v50, v51
    v_mfma_f32_16x16x32_bf16 a[108:111], v[120:123], a[144:147], a[108:111]
    s_add_u32 s29, s29, 0x2000
    v_exp_f32 v52, v52
    ds_read_b128 a[140:143], v4 offset:16384
    v_mfma_f32_16x16x32_bf16 a[112:115], v[96:99], a[152:155], a[112:115]
    buffer_load_dwordx4 v13, s[16:19], s29 offen offset:0 nt lds
    v_mfma_f32_16x16x32_bf16 a[112:115], v[100:103], a[156:159], a[112:115]
    v_exp_f32 v53, v53
    v_mfma_f32_16x16x32_bf16 a[116:119], v[108:111], a[156:159], a[116:119]
    v_cvt_pk_bf16_f32 v78, v52, v53
    v_mfma_f32_16x16x32_bf16 a[116:119], v[104:107], a[152:155], a[116:119]
    v_exp_f32 v54, v54
    v_mfma_f32_16x16x32_bf16 a[120:123], v[112:115], a[152:155], a[120:123]
    buffer_load_dwordx4 v14, s[16:19], s29 offen offset:1024 nt lds
    v_mfma_f32_16x16x32_bf16 a[120:123], v[116:119], a[156:159], a[120:123]
    v_exp_f32 v55, v55
    v_mfma_f32_16x16x32_bf16 a[124:127], v[124:127], a[156:159], a[124:127]
    v_cvt_pk_bf16_f32 v79, v54, v55
    v_mfma_f32_16x16x32_bf16 a[124:127], v[120:123], a[152:155], a[124:127]
    s_waitcnt lgkmcnt(0)
L_ep1B:
    v_mfma_f32_16x16x32_bf16 v[32:35], a[128:131], v[160:163], v[128:131]
    ds_read_b64_tr_b16 a[144:145], v5 offset:0
    ds_read_b64_tr_b16 a[146:147], v5 offset:4096
    v_mfma_f32_16x16x32_bf16 v[32:35], a[132:135], v[164:167], v[32:35]
    v_exp_f32 v56, v56
    v_mfma_f32_16x16x32_bf16 v[32:35], a[136:139], v[168:171], v[32:35]
    ds_read_b64_tr_b16 a[148:149], v5 offset:8192
    ds_read_b64_tr_b16 a[150:151], v5 offset:12288
    v_mfma_f32_16x16x32_bf16 v[32:35], a[140:143], v[172:175], v[32:35]
    v_exp_f32 v57, v57
    v_mfma_f32_16x16x32_bf16 v[36:39], a[140:143], v[188:191], v[132:135]
    ds_read_b64_tr_b16 a[152:153], v6 offset:0
    ds_read_b64_tr_b16 a[154:155], v6 offset:4096
    v_mfma_f32_16x16x32_bf16 v[36:39], a[136:139], v[184:187], v[36:39]
    v_exp_f32 v58, v58
    v_mfma_f32_16x16x32_bf16 v[36:39], a[132:135], v[180:183], v[36:39]
    ds_read_b64_tr_b16 a[156:157], v6 offset:8192
    ds_read_b64_tr_b16 a[158:159], v6 offset:12288
    v_mfma_f32_16x16x32_bf16 v[36:39], a[128:131], v[176:179], v[36:39]
    v_exp_f32 v59, v59
    v_mfma_f32_16x16x32_bf16 v[40:43], a[128:131], v[192:195], v[136:139]
    v_cvt_pk_bf16_f32 v86, v56, v57
    v_cvt_pk_bf16_f32 v87, v58, v59
    v_mfma_f32_16x16x32_bf16 v[40:43], a[132:135], v[196:199], v[40:43]
    v_exp_f32 v60, v60
    v_mfma_f32_16x16x32_bf16 v[40:43], a[136:139], v[200:203], v[40:43]
    v_mfma_f32_16x16x32_bf16 v[40:43], a[140:143], v[204:207], v[40:43]
    v_exp_f32 v61, v61
    v_mfma_f32_16x16x32_bf16 v[44:47], a[140:143], v[220:223], v[140:143]
    v_cvt_pk_bf16_f32 v94, v60, v61
    v_mfma_f32_16x16x32_bf16 v[44:47], a[136:139], v[216:219], v[44:47]
    v_exp_f32 v62, v62
    v_mfma_f32_16x16x32_bf16 v[44:47], a[132:135], v[212:215], v[44:47]
    v_mfma_f32_16x16x32_bf16 v[44:47], a[128:131], v[208:211], v[44:47]
    v_exp_f32 v63, v63
    v_mfma_f32_16x16x32_bf16 v[144:147], v[64:67], a[160:163], v[144:147]
    v_cvt_pk_bf16_f32 v95, v62, v63
    v_mfma_f32_16x16x32_bf16 v[144:147], v[68:71], a[160:163], v[144:147]
    s_waitcnt lgkmcnt(0)
    v_exp_f32 v32, v32
    v_mfma_f32_16x16x32_bf16 a[0:3], v[64:67], a[144:147], a[0:3]
    v_mfma_f32_16x16x32_bf16 a[0:3], v[68:71], a[148:151], a[0:3]
    v_exp_f32 v33, v33
    ds_read_b128 a[128:131], v1 offset:20480
    v_mfma_f32_16x16x32_bf16 a[4:7], v[76:79], a[148:151], a[4:7]
    v_cvt_pk_bf16_f32 v96, v32, v33
    v_mfma_f32_16x16x32_bf16 a[4:7], v[72:75], a[144:147], a[4:7]
    v_exp_f32 v34, v34
    ds_read_b128 a[132:135], v2 offset:20480
    v_mfma_f32_16x16x32_bf16 a[8:11], v[80:83], a[144:147], a[8:11]
    v_mfma_f32_16x16x32_bf16 a[8:11], v[84:87], a[148:151], a[8:11]
    v_exp_f32 v35, v35
    ds_read_b128 a[136:139], v3 offset:20480
    v_mfma_f32_16x16x32_bf16 a[12:15], v[92:95], a[148:151], a[12:15]
    v_cvt_pk_bf16_f32 v97, v34, v35
    v_mfma_f32_16x16x32_bf16 a[12:15], v[88:91], a[144:147], a[12:15]
    v_exp_f32 v36, v36
    ds_read_b128 a[140:143], v4 offset:20480
    v_mfma_f32_16x16x32_bf16 a[16:19], v[64:67], a[152:155], a[16:19]
    buffer_load_dwordx4 v15, s[16:19], s29 offen offset:2048 nt lds
    v_mfma_f32_16x16x32_bf16 a[16:19], v[68:71], a[156:159], a[16:19]
    v_exp_f32 v37, v37
    v_mfma_f32_16x16x32_bf16 a[20:23], v[76:79], a[156:159], a[20:23]
    v_cvt_pk_bf16_f32 v104, v36, v37
    v_mfma_f32_16x16x32_bf16 a[20:23], v[72:75], a[152:155], a[20:23]
    v_exp_f32 v38, v38
    v_mfma_f32_16x16x32_bf16 a[24:27], v[80:83], a[152:155], a[24:27]
    buffer_load_dwordx4 v16, s[16:19], s29 offen offset:3072 nt lds
    v_mfma_f32_16x16x32_bf16 a[24:27], v[84:87], a[156:159], a[24:27]
    v_exp_f32 v39, v39
    v_mfma_f32_16x16x32_bf16 a[28:31], v[92:95], a[156:159], a[28:31]
    v_cvt_pk_bf16_f32 v105, v38, v39
    v_mfma_f32_16x16x32_bf16 a[28:31], v[88:91], a[152:155], a[28:31]
    s_waitcnt lgkmcnt(0)
    v_mfma_f32_16x16x32_bf16 v[48:51], a[128:131], v[160:163], v[128:131]
    ds_read_b64_tr_b16 a[144:145], v7 offset:0
    ds_read_b64_tr_b16 a[146:147], v7 offset:4096
    v_mfma_f32_16x16x32_bf16 v[48:51], a[132:135], v[164:167], v[48:51]
    v_exp_f32 v40, v40
    v_mfma_f32_16x16x32_bf16 v[48:51], a[136:139], v[168:171], v[48:51]
    ds_read_b64_tr_b16 a[148:149], v7 offset:8192
    ds_read_b64_tr_b16 a[150:151], v7 offset:12288
    v_mfma_f32_16x16x32_bf16 v[48:51], a[140:143], v[172:175], v[48:51]
    v_exp_f32 v41, v41
    v_mfma_f32_16x16x32_bf16 v[52:55], a[140:143], v[188:191], v[132:135]
    ds_read_b64_tr_b16 a[152:153], v8 offset:0
    ds_read_b64_tr_b16 a[154:155], v8 offset:4096
    v_mfma_f32_16x16x32_bf16 v[52:55], a[136:139], v[184:187], v[52:55]
    v_exp_f32 v42, v42
    v_mfma_f32_16x16x32_bf16 v[52:55], a[132:135], v[180:183], v[52:55]
    ds_read_b64_tr_b16 a[156:157], v8 offset:8192
    ds_read_b64_tr_b16 a[158:159], v8 offset:12288
    v_mfma_f32_16x16x32_bf16 v[52:55], a[128:131], v[176:179], v[52:55]
    v_exp_f32 v43, v43
    v_mfma_f32_16x16x32_bf16 v[56:59], a[128:131], v[192:195], v[136:139]
    v_cvt_pk_bf16_f32 v112, v40, v41
    v_cvt_pk_bf16_f32 v113, v42, v43
    v_mfma_f32_16x16x32_bf16 v[56:59], a[132:135], v[196:199], v[56:59]
    v_exp_f32 v44, v44
    v_mfma_f32_16x16x32_bf16 v[56:59], a[136:139], v[200:203], v[56:59]
    v_mfma_f32_16x16x32_bf16 v[56:59], a[140:143], v[204:207], v[56:59]
    v_exp_f32 v45, v45
    v_mfma_f32_16x16x32_bf16 v[60:63], a[140:143], v[220:223], v[140:143]
    v_cvt_pk_bf16_f32 v120, v44, v45
    v_mfma_f32_16x16x32_bf16 v[60:63], a[136:139], v[216:219], v[60:63]
    v_exp_f32 v46, v46
    v_mfma_f32_16x16x32_bf16 v[60:63], a[132:135], v[212:215], v[60:63]
    v_mfma_f32_16x16x32_bf16 v[60:63], a[128:131], v[208:211], v[60:63]
    v_exp_f32 v47, v47
    v_mfma_f32_16x16x32_bf16 v[144:147], v[72:75], a[164:167], v[144:147]
    v_cvt_pk_bf16_f32 v121, v46, v47
    v_mfma_f32_16x16x32_bf16 v[144:147], v[76:79], a[164:167], v[144:147]
    s_waitcnt lgkmcnt(0)
    v_exp_f32 v48, v48
    v_mfma_f32_16x16x32_bf16 a[32:35], v[64:67], a[144:147], a[32:35]
    v_mfma_f32_16x16x32_bf16 a[32:35], v[68:71], a[148:151], a[32:35]
    v_exp_f32 v49, v49
    ds_read_b128 a[128:131], v1 offset:24576
    v_mfma_f32_16x16x32_bf16 a[36:39], v[76:79], a[148:151], a[36:39]
    v_cvt_pk_bf16_f32 v98, v48, v49
    v_mfma_f32_16x16x32_bf16 a[36:39], v[72:75], a[144:147], a[36:39]
    v_exp_f32 v50, v50
    ds_read_b128 a[132:135], v2 offset:24576
    v_mfma_f32_16x16x32_bf16 a[40:43], v[80:83], a[144:147], a[40:43]
    v_mfma_f32_16x16x32_bf16 a[40:43], v[84:87], a[148:151], a[40:43]
    s_mov_b32 m0, s49
    v_exp_f32 v51, v51
    ds_read_b128 a[136:139], v3 offset:24576
    v_mfma_f32_16x16x32_bf16 a[44:47], v[92:95], a[148:151], a[44:47]
    v_cvt_pk_bf16_f32 v99, v50, v51
    v_mfma_f32_16x16x32_bf16 a[44:47], v[88:91], a[144:147], a[44:47]
    s_add_u32 s29, s29, 0x2000
    v_exp_f32 v52, v52
    ds_read_b128 a[140:143], v4 offset:24576
    v_mfma_f32_16x16x32_bf16 a[48:51], v[64:67], a[152:155], a[48:51]
    buffer_load_dwordx4 v13, s[16:19], s29 offen offset:0 nt lds
    v_mfma_f32_16x16x32_bf16 a[48:51], v[68:71], a[156:159], a[48:51]
    v_exp_f32 v53, v53
    v_mfma_f32_16x16x32_bf16 a[52:55], v[76:79], a[156:159], a[52:55]
    v_cvt_pk_bf16_f32 v106, v52, v53
    v_mfma_f32_16x16x32_bf16 a[52:55], v[72:75], a[152:155], a[52:55]
    v_exp_f32 v54, v54
    v_mfma_f32_16x16x32_bf16 a[56:59], v[80:83], a[152:155], a[56:59]
    buffer_load_dwordx4 v14, s[16:19], s29 offen offset:1024 nt lds
    v_mfma_f32_16x16x32_bf16 a[56:59], v[84:87], a[156:159], a[56:59]
    v_exp_f32 v55, v55
    v_mfma_f32_16x16x32_bf16 a[60:63], v[92:95], a[156:159], a[60:63]
    v_cvt_pk_bf16_f32 v107, v54, v55
    v_mfma_f32_16x16x32_bf16 a[60:63], v[88:91], a[152:155], a[60:63]
    s_waitcnt lgkmcnt(0)
    v_mfma_f32_16x16x32_bf16 v[32:35], a[128:131], v[160:163], v[128:131]
    ds_read_b64_tr_b16 a[144:145], v9 offset:0
    ds_read_b64_tr_b16 a[146:147], v9 offset:4096
    v_mfma_f32_16x16x32_bf16 v[32:35], a[132:135], v[164:167], v[32:35]
    v_exp_f32 v56, v56
    v_mfma_f32_16x16x32_bf16 v[32:35], a[136:139], v[168:171], v[32:35]
    ds_read_b64_tr_b16 a[148:149], v9 offset:8192
    ds_read_b64_tr_b16 a[150:151], v9 offset:12288
    v_mfma_f32_16x16x32_bf16 v[32:35], a[140:143], v[172:175], v[32:35]
    v_exp_f32 v57, v57
    v_mfma_f32_16x16x32_bf16 v[36:39], a[140:143], v[188:191], v[132:135]
    ds_read_b64_tr_b16 a[152:153], v10 offset:0
    ds_read_b64_tr_b16 a[154:155], v10 offset:4096
    v_mfma_f32_16x16x32_bf16 v[36:39], a[136:139], v[184:187], v[36:39]
    v_exp_f32 v58, v58
    v_mfma_f32_16x16x32_bf16 v[36:39], a[132:135], v[180:183], v[36:39]
    ds_read_b64_tr_b16 a[156:157], v10 offset:8192
    ds_read_b64_tr_b16 a[158:159], v10 offset:12288
    v_mfma_f32_16x16x32_bf16 v[36:39], a[128:131], v[176:179], v[36:39]
    v_exp_f32 v59, v59
    v_mfma_f32_16x16x32_bf16 v[40:43], a[128:131], v[192:195], v[136:139]
    v_cvt_pk_bf16_f32 v114, v56, v57
    v_cvt_pk_bf16_f32 v115, v58, v59
    v_mfma_f32_16x16x32_bf16 v[40:43], a[132:135], v[196:199], v[40:43]
    v_exp_f32 v60, v60
    v_mfma_f32_16x16x32_bf16 v[40:43], a[136:139], v[200:203], v[40:43]
    v_mfma_f32_16x16x32_bf16 v[40:43], a[140:143], v[204:207], v[40:43]
    v_exp_f32 v61, v61
    v_mfma_f32_16x16x32_bf16 v[44:47], a[140:143], v[220:223], v[140:143]
    v_cvt_pk_bf16_f32 v122, v60, v61
    v_mfma_f32_16x16x32_bf16 v[44:47], a[136:139], v[216:219], v[44:47]
    v_exp_f32 v62, v62
    v_mfma_f32_16x16x32_bf16 v[44:47], a[132:135], v[212:215], v[44:47]
    v_mfma_f32_16x16x32_bf16 v[44:47], a[128:131], v[208:211], v[44:47]
    v_exp_f32 v63, v63
    v_mfma_f32_16x16x32_bf16 v[144:147], v[80:83], a[168:171], v[144:147]
    v_cvt_pk_bf16_f32 v123, v62, v63
    v_mfma_f32_16x16x32_bf16 v[144:147], v[84:87], a[168:171], v[144:147]
    s_waitcnt lgkmcnt(0)
    v_exp_f32 v32, v32
    v_mfma_f32_16x16x32_bf16 a[64:67], v[64:67], a[144:147], a[64:67]
    v_mfma_f32_16x16x32_bf16 a[64:67], v[68:71], a[148:151], a[64:67]
    v_exp_f32 v33, v33
    ds_read_b128 a[128:131], v1 offset:28672
    v_mfma_f32_16x16x32_bf16 a[68:71], v[76:79], a[148:151], a[68:71]
    v_cvt_pk_bf16_f32 v100, v32, v33
    v_mfma_f32_16x16x32_bf16 a[68:71], v[72:75], a[144:147], a[68:71]
    v_exp_f32 v34, v34
    ds_read_b128 a[132:135], v2 offset:28672
    v_mfma_f32_16x16x32_bf16 a[72:75], v[80:83], a[144:147], a[72:75]
    v_mfma_f32_16x16x32_bf16 a[72:75], v[84:87], a[148:151], a[72:75]
    v_exp_f32 v35, v35
    ds_read_b128 a[136:139], v3 offset:28672
    v_mfma_f32_16x16x32_bf16 a[76:79], v[92:95], a[148:151], a[76:79]
    v_cvt_pk_bf16_f32 v101, v34, v35
    v_mfma_f32_16x16x32_bf16 a[76:79], v[88:91], a[144:147], a[76:79]
    v_exp_f32 v36, v36
    ds_read_b128 a[140:143], v4 offset:28672
    v_mfma_f32_16x16x32_bf16 a[80:83], v[64:67], a[152:155], a[80:83]
    buffer_load_dwordx4 v15, s[16:19], s29 offen offset:2048 nt lds
    v_mfma_f32_16x16x32_bf16 a[80:83], v[68:71], a[156:159], a[80:83]
    v_exp_f32 v37, v37
    v_mfma_f32_16x16x32_bf16 a[84:87], v[76:79], a[156:159], a[84:87]
    v_cvt_pk_bf16_f32 v108, v36, v37
    v_mfma_f32_16x16x32_bf16 a[84:87], v[72:75], a[152:155], a[84:87]
    v_exp_f32 v38, v38
    v_mfma_f32_16x16x32_bf16 a[88:91], v[80:83], a[152:155], a[88:91]
    buffer_load_dwordx4 v16, s[16:19], s29 offen offset:3072 nt lds
    v_mfma_f32_16x16x32_bf16 a[88:91], v[84:87], a[156:159], a[88:91]
    v_exp_f32 v39, v39
    v_mfma_f32_16x16x32_bf16 a[92:95], v[92:95], a[156:159], a[92:95]
    v_cvt_pk_bf16_f32 v109, v38, v39
    v_mfma_f32_16x16x32_bf16 a[92:95], v[88:91], a[152:155], a[92:95]
    s_waitcnt lgkmcnt(0)
    v_mfma_f32_16x16x32_bf16 v[48:51], a[128:131], v[160:163], v[128:131]
    ds_read_b64_tr_b16 a[144:145], v11 offset:0
    ds_read_b64_tr_b16 a[146:147], v11 offset:4096
    v_mfma_f32_16x16x32_bf16 v[48:51], a[132:135], v[164:167], v[48:51]
    v_exp_f32 v40, v40
    v_mfma_f32_16x16x32_bf16 v[48:51], a[136:139], v[168:171], v[48:51]
    ds_read_b64_tr_b16 a[148:149], v11 offset:8192
    ds_read_b64_tr_b16 a[150:151], v11 offset:12288
    v_mfma_f32_16x16x32_bf16 v[48:51], a[140:143], v[172:175], v[48:51]
    v_exp_f32 v41, v41
    v_mfma_f32_16x16x32_bf16 v[52:55], a[140:143], v[188:191], v[132:135]
    ds_read_b64_tr_b16 a[152:153], v12 offset:0
    ds_read_b64_tr_b16 a[154:155], v12 offset:4096
    v_mfma_f32_16x16x32_bf16 v[52:55], a[136:139], v[184:187], v[52:55]
    v_exp_f32 v42, v42
    v_mfma_f32_16x16x32_bf16 v[52:55], a[132:135], v[180:183], v[52:55]
    ds_read_b64_tr_b16 a[156:157], v12 offset:8192
    ds_read_b64_tr_b16 a[158:159], v12 offset:12288
    v_mfma_f32_16x16x32_bf16 v[52:55], a[128:131], v[176:179], v[52:55]
    v_exp_f32 v43, v43
    v_mfma_f32_16x16x32_bf16 v[56:59], a[128:131], v[192:195], v[136:139]
    v_cvt_pk_bf16_f32 v116, v40, v41
    v_cvt_pk_bf16_f32 v117, v42, v43
    v_mfma_f32_16x16x32_bf16 v[56:59], a[132:135], v[196:199], v[56:59]
    v_exp_f32 v44, v44
    v_mfma_f32_16x16x32_bf16 v[56:59], a[136:139], v[200:203], v[56:59]
    v_mfma_f32_16x16x32_bf16 v[56:59], a[140:143], v[204:207], v[56:59]
    v_exp_f32 v45, v45
    v_mfma_f32_16x16x32_bf16 v[60:63], a[140:143], v[220:223], v[140:143]
    v_cvt_pk_bf16_f32 v124, v44, v45
    v_mfma_f32_16x16x32_bf16 v[60:63], a[136:139], v[216:219], v[60:63]
    v_exp_f32 v46, v46
    v_mfma_f32_16x16x32_bf16 v[60:63], a[132:135], v[212:215], v[60:63]
    v_mfma_f32_16x16x32_bf16 v[60:63], a[128:131], v[208:211], v[60:63]
    v_exp_f32 v47, v47
    v_mfma_f32_16x16x32_bf16 v[144:147], v[88:91], a[172:175], v[144:147]
    v_cvt_pk_bf16_f32 v125, v46, v47
    v_mfma_f32_16x16x32_bf16 v[144:147], v[92:95], a[172:175], v[144:147]
    s_waitcnt vmcnt(16) lgkmcnt(0)
    v_exp_f32 v48, v48
    v_mfma_f32_16x16x32_bf16 a[96:99], v[64:67], a[144:147], a[96:99]
    s_barrier
    v_mfma_f32_16x16x32_bf16 a[96:99], v[68:71], a[148:151], a[96:99]
    v_exp_f32 v49, v49
    ds_read_b128 a[128:131], v1 offset:32768
    v_mfma_f32_16x16x32_bf16 a[100:103], v[76:79], a[148:151], a[100:103]
    v_cvt_pk_bf16_f32 v102, v48, v49
    v_mfma_f32_16x16x32_bf16 a[100:103], v[72:75], a[144:147], a[100:103]
    v_exp_f32 v50, v50
    ds_read_b128 a[132:135], v2 offset:32768
    v_mfma_f32_16x16x32_bf16 a[104:107], v[80:83], a[144:147], a[104:107]
    v_mfma_f32_16x16x32_bf16 a[104:107], v[84:87], a[148:151], a[104:107]
    s_mov_b32 m0, s50
    v_exp_f32 v51, v51
    ds_read_b128 a[136:139], v3 offset:32768
    v_mfma_f32_16x16x32_bf16 a[108:111], v[92:95], a[148:151], a[108:111]
    v_cvt_pk_bf16_f32 v103, v50, v51
    v_mfma_f32_16x16x32_bf16 a[108:111], v[88:91], a[144:147], a[108:111]
    s_add_u32 s29, s29, 0x2000
    v_exp_f32 v52, v52
    ds_read_b128 a[140:143], v4 offset:32768
    v_mfma_f32_16x16x32_bf16 a[112:115], v[64:67], a[152:155], a[112:115]
    buffer_load_dwordx4 v13, s[16:19], s29 offen offset:0 nt lds
    v_mfma_f32_16x16x32_bf16 a[112:115], v[68:71], a[156:159], a[112:115]
    v_exp_f32 v53, v53
    v_mfma_f32_16x16x32_bf16 a[116:119], v[76:79], a[156:159], a[116:119]
    v_cvt_pk_bf16_f32 v110, v52, v53
    v_mfma_f32_16x16x32_bf16 a[116:119], v[72:75], a[152:155], a[116:119]
    v_exp_f32 v54, v54
    v_mfma_f32_16x16x32_bf16 a[120:123], v[80:83], a[152:155], a[120:123]
    buffer_load_dwordx4 v14, s[16:19], s29 offen offset:1024 nt lds
    v_mfma_f32_16x16x32_bf16 a[120:123], v[84:87], a[156:159], a[120:123]
    v_exp_f32 v55, v55
    v_mfma_f32_16x16x32_bf16 a[124:127], v[92:95], a[156:159], a[124:127]
    v_cvt_pk_bf16_f32 v111, v54, v55
    v_mfma_f32_16x16x32_bf16 a[124:127], v[88:91], a[152:155], a[124:127]
    s_waitcnt lgkmcnt(0)
    v_mfma_f32_16x16x32_bf16 v[32:35], a[128:131], v[160:163], v[128:131]
    ds_read_b64_tr_b16 a[144:145], v5 offset:16384
    ds_read_b64_tr_b16 a[146:147], v5 offset:20480
    v_mfma_f32_16x16x32_bf16 v[32:35], a[132:135], v[164:167], v[32:35]
    v_exp_f32 v56, v56
    v_mfma_f32_16x16x32_bf16 v[32:35], a[136:139], v[168:171], v[32:35]
    ds_read_b64_tr_b16 a[148:149], v5 offset:24576
    ds_read_b64_tr_b16 a[150:151], v5 offset:28672
    v_mfma_f32_16x16x32_bf16 v[32:35], a[140:143], v[172:175], v[32:35]
    v_exp_f32 v57, v57
    v_mfma_f32_16x16x32_bf16 v[36:39], a[140:143], v[188:191], v[132:135]
    ds_read_b64_tr_b16 a[152:153], v6 offset:16384
    ds_read_b64_tr_b16 a[154:155], v6 offset:20480
    v_mfma_f32_16x16x32_bf16 v[36:39], a[136:139], v[184:187], v[36:39]
    v_exp_f32 v58, v58
    v_mfma_f32_16x16x32_bf16 v[36:39], a[132:135], v[180:183], v[36:39]
    ds_read_b64_tr_b16 a[156:157], v6 offset:24576
    ds_read_b64_tr_b16 a[158:159], v6 offset:28672
    v_mfma_f32_16x16x32_bf16 v[36:39], a[128:131], v[176:179], v[36:39]
    v_exp_f32 v59, v59
    v_mfma_f32_16x16x32_bf16 v[40:43], a[128:131], v[192:195], v[136:139]
    v_cvt_pk_bf16_f32 v118, v56, v57
    v_cvt_pk_bf16_f32 v119, v58, v59
    v_mfma_f32_16x16x32_bf16 v[40:43], a[132:135], v[196:199], v[40:43]
    v_exp_f32 v60, v60
    v_mfma_f32_16x16x32_bf16 v[40:43], a[136:139], v[200:203], v[40:43]
    v_mfma_f32_16x16x32_bf16 v[40:43], a[140:143], v[204:207], v[40:43]
    v_exp_f32 v61, v61
    v_mfma_f32_16x16x32_bf16 v[44:47], a[140:143], v[220:223], v[140:143]
    v_cvt_pk_bf16_f32 v126, v60, v61
    v_mfma_f32_16x16x32_bf16 v[44:47], a[136:139], v[216:219], v[44:47]
    v_exp_f32 v62, v62
    v_mfma_f32_16x16x32_bf16 v[44:47], a[132:135], v[212:215], v[44:47]
    v_mfma_f32_16x16x32_bf16 v[44:47], a[128:131], v[208:211], v[44:47]
    v_exp_f32 v63, v63
    v_mfma_f32_16x16x32_bf16 v[144:147], v[96:99], a[160:163], v[144:147]
    v_cvt_pk_bf16_f32 v127, v62, v63
    v_mfma_f32_16x16x32_bf16 v[144:147], v[100:103], a[160:163], v[144:147]
    s_waitcnt lgkmcnt(0)
    v_exp_f32 v32, v32
    v_mfma_f32_16x16x32_bf16 a[0:3], v[96:99], a[144:147], a[0:3]
    v_mfma_f32_16x16x32_bf16 a[0:3], v[100:103], a[148:151], a[0:3]
    v_exp_f32 v33, v33
    ds_read_b128 a[128:131], v1 offset:36864
    v_mfma_f32_16x16x32_bf16 a[4:7], v[108:111], a[148:151], a[4:7]
    v_cvt_pk_bf16_f32 v64, v32, v33
    v_mfma_f32_16x16x32_bf16 a[4:7], v[104:107], a[144:147], a[4:7]
    v_exp_f32 v34, v34
    ds_read_b128 a[132:135], v2 offset:36864
    v_mfma_f32_16x16x32_bf16 a[8:11], v[112:115], a[144:147], a[8:11]
    v_mfma_f32_16x16x32_bf16 a[8:11], v[116:119], a[148:151], a[8:11]
    v_exp_f32 v35, v35
    ds_read_b128 a[136:139], v3 offset:36864
    v_mfma_f32_16x16x32_bf16 a[12:15], v[124:127], a[148:151], a[12:15]
    v_cvt_pk_bf16_f32 v65, v34, v35
    v_mfma_f32_16x16x32_bf16 a[12:15], v[120:123], a[144:147], a[12:15]
    v_exp_f32 v36, v36
    ds_read_b128 a[140:143], v4 offset:36864
    v_mfma_f32_16x16x32_bf16 a[16:19], v[96:99], a[152:155], a[16:19]
    buffer_load_dwordx4 v15, s[16:19], s29 offen offset:2048 nt lds
    v_mfma_f32_16x16x32_bf16 a[16:19], v[100:103], a[156:159], a[16:19]
    v_exp_f32 v37, v37
    v_mfma_f32_16x16x32_bf16 a[20:23], v[108:111], a[156:159], a[20:23]
    v_cvt_pk_bf16_f32 v72, v36, v37
    v_mfma_f32_16x16x32_bf16 a[20:23], v[104:107], a[152:155], a[20:23]
    v_exp_f32 v38, v38
    v_mfma_f32_16x16x32_bf16 a[24:27], v[112:115], a[152:155], a[24:27]
    buffer_load_dwordx4 v16, s[16:19], s29 offen offset:3072 nt lds
    v_mfma_f32_16x16x32_bf16 a[24:27], v[116:119], a[156:159], a[24:27]
    v_exp_f32 v39, v39
    v_mfma_f32_16x16x32_bf16 a[28:31], v[124:127], a[156:159], a[28:31]
    v_cvt_pk_bf16_f32 v73, v38, v39
    v_mfma_f32_16x16x32_bf16 a[28:31], v[120:123], a[152:155], a[28:31]
    s_waitcnt lgkmcnt(0)
    v_mfma_f32_16x16x32_bf16 v[48:51], a[128:131], v[160:163], v[128:131]
    ds_read_b64_tr_b16 a[144:145], v7 offset:16384
    ds_read_b64_tr_b16 a[146:147], v7 offset:20480
    v_mfma_f32_16x16x32_bf16 v[48:51], a[132:135], v[164:167], v[48:51]
    v_exp_f32 v40, v40
    v_mfma_f32_16x16x32_bf16 v[48:51], a[136:139], v[168:171], v[48:51]
    ds_read_b64_tr_b16 a[148:149], v7 offset:24576
    ds_read_b64_tr_b16 a[150:151], v7 offset:28672
    v_mfma_f32_16x16x32_bf16 v[48:51], a[140:143], v[172:175], v[48:51]
    v_exp_f32 v41, v41
    v_mfma_f32_16x16x32_bf16 v[52:55], a[140:143], v[188:191], v[132:135]
    ds_read_b64_tr_b16 a[152:153], v8 offset:16384
    ds_read_b64_tr_b16 a[154:155], v8 offset:20480
    v_mfma_f32_16x16x32_bf16 v[52:55], a[136:139], v[184:187], v[52:55]
    v_exp_f32 v42, v42
    v_mfma_f32_16x16x32_bf16 v[52:55], a[132:135], v[180:183], v[52:55]
    ds_read_b64_tr_b16 a[156:157], v8 offset:24576
    ds_read_b64_tr_b16 a[158:159], v8 offset:28672
    v_mfma_f32_16x16x32_bf16 v[52:55], a[128:131], v[176:179], v[52:55]
    v_exp_f32 v43, v43
    v_mfma_f32_16x16x32_bf16 v[56:59], a[128:131], v[192:195], v[136:139]
    v_cvt_pk_bf16_f32 v80, v40, v41
    v_cvt_pk_bf16_f32 v81, v42, v43
    v_mfma_f32_16x16x32_bf16 v[56:59], a[132:135], v[196:199], v[56:59]
    v_exp_f32 v44, v44
    v_mfma_f32_16x16x32_bf16 v[56:59], a[136:139], v[200:203], v[56:59]
    v_mfma_f32_16x16x32_bf16 v[56:59], a[140:143], v[204:207], v[56:59]
    v_exp_f32 v45, v45
    v_mfma_f32_16x16x32_bf16 v[60:63], a[140:143], v[220:223], v[140:143]
    v_cvt_pk_bf16_f32 v88, v44, v45
    v_mfma_f32_16x16x32_bf16 v[60:63], a[136:139], v[216:219], v[60:63]
    v_exp_f32 v46, v46
    v_mfma_f32_16x16x32_bf16 v[60:63], a[132:135], v[212:215], v[60:63]
    v_mfma_f32_16x16x32_bf16 v[60:63], a[128:131], v[208:211], v[60:63]
    v_exp_f32 v47, v47
    v_mfma_f32_16x16x32_bf16 v[144:147], v[104:107], a[164:167], v[144:147]
    v_cvt_pk_bf16_f32 v89, v46, v47
    v_mfma_f32_16x16x32_bf16 v[144:147], v[108:111], a[164:167], v[144:147]
    s_waitcnt lgkmcnt(0)
    v_exp_f32 v48, v48
    v_mfma_f32_16x16x32_bf16 a[32:35], v[96:99], a[144:147], a[32:35]
    v_mfma_f32_16x16x32_bf16 a[32:35], v[100:103], a[148:151], a[32:35]
    v_exp_f32 v49, v49
    ds_read_b128 a[128:131], v1 offset:40960
    v_mfma_f32_16x16x32_bf16 a[36:39], v[108:111], a[148:151], a[36:39]
    v_cvt_pk_bf16_f32 v66, v48, v49
    v_mfma_f32_16x16x32_bf16 a[36:39], v[104:107], a[144:147], a[36:39]
    v_exp_f32 v50, v50
    ds_read_b128 a[132:135], v2 offset:40960
    v_mfma_f32_16x16x32_bf16 a[40:43], v[112:115], a[144:147], a[40:43]
    v_mfma_f32_16x16x32_bf16 a[40:43], v[116:119], a[148:151], a[40:43]
    s_mov_b32 m0, s51
    v_exp_f32 v51, v51
    ds_read_b128 a[136:139], v3 offset:40960
    v_mfma_f32_16x16x32_bf16 a[44:47], v[124:127], a[148:151], a[44:47]
    v_cvt_pk_bf16_f32 v67, v50, v51
    v_mfma_f32_16x16x32_bf16 a[44:47], v[120:123], a[144:147], a[44:47]
    s_add_u32 s29, s29, 0x2000
    v_exp_f32 v52, v52
    ds_read_b128 a[140:143], v4 offset:40960
    v_mfma_f32_16x16x32_bf16 a[48:51], v[96:99], a[152:155], a[48:51]
    buffer_load_dwordx4 v13, s[16:19], s29 offen offset:0 nt lds
    v_mfma_f32_16x16x32_bf16 a[48:51], v[100:103], a[156:159], a[48:51]
    v_exp_f32 v53, v53
    v_mfma_f32_16x16x32_bf16 a[52:55], v[108:111], a[156:159], a[52:55]
    v_cvt_pk_bf16_f32 v74, v52, v53
    v_mfma_f32_16x16x32_bf16 a[52:55], v[104:107], a[152:155], a[52:55]
    v_exp_f32 v54, v54
    v_mfma_f32_16x16x32_bf16 a[56:59], v[112:115], a[152:155], a[56:59]
    buffer_load_dwordx4 v14, s[16:19], s29 offen offset:1024 nt lds
    v_mfma_f32_16x16x32_bf16 a[56:59], v[116:119], a[156:159], a[56:59]
    v_exp_f32 v55, v55
    v_mfma_f32_16x16x32_bf16 a[60:63], v[124:127], a[156:159], a[60:63]
    v_cvt_pk_bf16_f32 v75, v54, v55
    v_mfma_f32_16x16x32_bf16 a[60:63], v[120:123], a[152:155], a[60:63]
    s_waitcnt lgkmcnt(0)
    v_mfma_f32_16x16x32_bf16 v[32:35], a[128:131], v[160:163], v[128:131]
    ds_read_b64_tr_b16 a[144:145], v9 offset:16384
    ds_read_b64_tr_b16 a[146:147], v9 offset:20480
    v_mfma_f32_16x16x32_bf16 v[32:35], a[132:135], v[164:167], v[32:35]
    v_exp_f32 v56, v56
    v_mfma_f32_16x16x32_bf16 v[32:35], a[136:139], v[168:171], v[32:35]
    ds_read_b64_tr_b16 a[148:149], v9 offset:24576
    ds_read_b64_tr_b16 a[150:151], v9 offset:28672
    v_mfma_f32_16x16x32_bf16 v[32:35], a[140:143], v[172:175], v[32:35]
    v_exp_f32 v57, v57
    v_mfma_f32_16x16x32_bf16 v[36:39], a[140:143], v[188:191], v[132:135]
    ds_read_b64_tr_b16 a[152:153], v10 offset:16384
    ds_read_b64_tr_b16 a[154:155], v10 offset:20480
    v_mfma_f32_16x16x32_bf16 v[36:39], a[136:139], v[184:187], v[36:39]
    v_exp_f32 v58, v58
    v_mfma_f32_16x16x32_bf16 v[36:39], a[132:135], v[180:183], v[36:39]
    ds_read_b64_tr_b16 a[156:157], v10 offset:24576
    ds_read_b64_tr_b16 a[158:159], v10 offset:28672
    v_mfma_f32_16x16x32_bf16 v[36:39], a[128:131], v[176:179], v[36:39]
    v_exp_f32 v59, v59
    v_mfma_f32_16x16x32_bf16 v[40:43], a[128:131], v[192:195], v[136:139]
    v_cvt_pk_bf16_f32 v82, v56, v57
    v_cvt_pk_bf16_f32 v83, v58, v59
    v_mfma_f32_16x16x32_bf16 v[40:43], a[132:135], v[196:199], v[40:43]
    v_exp_f32 v60, v60
    v_mfma_f32_16x16x32_bf16 v[40:43], a[136:139], v[200:203], v[40:43]
    v_mfma_f32_16x16x32_bf16 v[40:43], a[140:143], v[204:207], v[40:43]
    v_exp_f32 v61, v61
    v_mfma_f32_16x16x32_bf16 v[44:47], a[140:143], v[220:223], v[140:143]
    v_cvt_pk_bf16_f32 v90, v60, v61
    v_mfma_f32_16x16x32_bf16 v[44:47], a[136:139], v[216:219], v[44:47]
    v_exp_f32 v62, v62
    v_mfma_f32_16x16x32_bf16 v[44:47], a[132:135], v[212:215], v[44:47]
    v_mfma_f32_16x16x32_bf16 v[44:47], a[128:131], v[208:211], v[44:47]
    v_exp_f32 v63, v63
    v_mfma_f32_16x16x32_bf16 v[144:147], v[112:115], a[168:171], v[144:147]
    v_cvt_pk_bf16_f32 v91, v62, v63
    v_mfma_f32_16x16x32_bf16 v[144:147], v[116:119], a[168:171], v[144:147]
    s_waitcnt lgkmcnt(0)
    v_exp_f32 v32, v32
    v_mfma_f32_16x16x32_bf16 a[64:67], v[96:99], a[144:147], a[64:67]
    v_mfma_f32_16x16x32_bf16 a[64:67], v[100:103], a[148:151], a[64:67]
    v_exp_f32 v33, v33
    ds_read_b128 a[128:131], v1 offset:45056
    v_mfma_f32_16x16x32_bf16 a[68:71], v[108:111], a[148:151], a[68:71]
    v_cvt_pk_bf16_f32 v68, v32, v33
    v_mfma_f32_16x16x32_bf16 a[68:71], v[104:107], a[144:147], a[68:71]
    v_exp_f32 v34, v34
    ds_read_b128 a[132:135], v2 offset:45056
    v_mfma_f32_16x16x32_bf16 a[72:75], v[112:115], a[144:147], a[72:75]
    v_mfma_f32_16x16x32_bf16 a[72:75], v[116:119], a[148:151], a[72:75]
    v_exp_f32 v35, v35
    ds_read_b128 a[136:139], v3 offset:45056
    v_mfma_f32_16x16x32_bf16 a[76:79], v[124:127], a[148:151], a[76:79]
    v_cvt_pk_bf16_f32 v69, v34, v35
    v_mfma_f32_16x16x32_bf16 a[76:79], v[120:123], a[144:147], a[76:79]
    v_exp_f32 v36, v36
    ds_read_b128 a[140:143], v4 offset:45056
    v_mfma_f32_16x16x32_bf16 a[80:83], v[96:99], a[152:155], a[80:83]
    buffer_load_dwordx4 v15, s[16:19], s29 offen offset:2048 nt lds
    v_mfma_f32_16x16x32_bf16 a[80:83], v[100:103], a[156:159], a[80:83]
    v_exp_f32 v37, v37
    v_mfma_f32_16x16x32_bf16 a[84:87], v[108:111], a[156:159], a[84:87]
    v_cvt_pk_bf16_f32 v76, v36, v37
    v_mfma_f32_16x16x32_bf16 a[84:87], v[104:107], a[152:155], a[84:87]
    v_exp_f32 v38, v38
    v_mfma_f32_16x16x32_bf16 a[88:91], v[112:115], a[152:155], a[88:91]
    buffer_load_dwordx4 v16, s[16:19], s29 offen offset:3072 nt lds
    v_mfma_f32_16x16x32_bf16 a[88:91], v[116:119], a[156:159], a[88:91]
    v_exp_f32 v39, v39
    v_mfma_f32_16x16x32_bf16 a[92:95], v[124:127], a[156:159], a[92:95]
    v_cvt_pk_bf16_f32 v77, v38, v39
    v_mfma_f32_16x16x32_bf16 a[92:95], v[120:123], a[152:155], a[92:95]
    s_waitcnt lgkmcnt(0)
    v_mfma_f32_16x16x32_bf16 v[48:51], a[128:131], v[160:163], v[128:131]
    ds_read_b64_tr_b16 a[144:145], v11 offset:16384
    ds_read_b64_tr_b16 a[146:147], v11 offset:20480
    v_mfma_f32_16x16x32_bf16 v[48:51], a[132:135], v[164:167], v[48:51]
    v_exp_f32 v40, v40
    v_mfma_f32_16x16x32_bf16 v[48:51], a[136:139], v[168:171], v[48:51]
    ds_read_b64_tr_b16 a[148:149], v11 offset:24576
    ds_read_b64_tr_b16 a[150:151], v11 offset:28672
    v_mfma_f32_16x16x32_bf16 v[48:51], a[140:143], v[172:175], v[48:51]
    v_exp_f32 v41, v41
    v_mfma_f32_16x16x32_bf16 v[52:55], a[140:143], v[188:191], v[132:135]
    ds_read_b64_tr_b16 a[152:153], v12 offset:16384
    ds_read_b64_tr_b16 a[154:155], v12 offset:20480
    v_mfma_f32_16x16x32_bf16 v[52:55], a[136:139], v[184:187], v[52:55]
    v_exp_f32 v42, v42
    v_mfma_f32_16x16x32_bf16 v[52:55], a[132:135], v[180:183], v[52:55]
    ds_read_b64_tr_b16 a[156:157], v12 offset:24576
    ds_read_b64_tr_b16 a[158:159], v12 offset:28672
    v_mfma_f32_16x16x32_bf16 v[52:55], a[128:131], v[176:179], v[52:55]
    v_exp_f32 v43, v43
    v_mfma_f32_16x16x32_bf16 v[56:59], a[128:131], v[192:195], v[136:139]
    v_cvt_pk_bf16_f32 v84, v40, v41
    v_cvt_pk_bf16_f32 v85, v42, v43
    v_mfma_f32_16x16x32_bf16 v[56:59], a[132:135], v[196:199], v[56:59]
    v_exp_f32 v44, v44
    v_mfma_f32_16x16x32_bf16 v[56:59], a[136:139], v[200:203], v[56:59]
    v_mfma_f32_16x16x32_bf16 v[56:59], a[140:143], v[204:207], v[56:59]
    v_exp_f32 v45, v45
    v_mfma_f32_16x16x32_bf16 v[60:63], a[140:143], v[220:223], v[140:143]
    v_cvt_pk_bf16_f32 v92, v44, v45
    v_mfma_f32_16x16x32_bf16 v[60:63], a[136:139], v[216:219], v[60:63]
    v_exp_f32 v46, v46
    v_mfma_f32_16x16x32_bf16 v[60:63], a[132:135], v[212:215], v[60:63]
    v_mfma_f32_16x16x32_bf16 v[60:63], a[128:131], v[208:211], v[60:63]
    v_exp_f32 v47, v47
    v_mfma_f32_16x16x32_bf16 v[144:147], v[120:123], a[172:175], v[144:147]
    v_cvt_pk_bf16_f32 v93, v46, v47
    v_mfma_f32_16x16x32_bf16 v[144:147], v[124:127], a[172:175], v[144:147]
    s_waitcnt vmcnt(16) lgkmcnt(0)
    v_exp_f32 v48, v48
    v_mfma_f32_16x16x32_bf16 a[96:99], v[96:99], a[144:147], a[96:99]
    s_barrier
    v_mfma_f32_16x16x32_bf16 a[96:99], v[100:103], a[148:151], a[96:99]
    v_exp_f32 v49, v49
    ds_read_b128 a[128:131], v1 offset:49152
    v_mfma_f32_16x16x32_bf16 a[100:103], v[108:111], a[148:151], a[100:103]
    v_cvt_pk_bf16_f32 v70, v48, v49
    v_mfma_f32_16x16x32_bf16 a[100:103], v[104:107], a[144:147], a[100:103]
    v_exp_f32 v50, v50
    ds_read_b128 a[132:135], v2 offset:49152
    v_mfma_f32_16x16x32_bf16 a[104:107], v[112:115], a[144:147], a[104:107]
    v_mfma_f32_16x16x32_bf16 a[104:107], v[116:119], a[148:151], a[104:107]
    s_mov_b32 m0, s52
    v_exp_f32 v51, v51
    ds_read_b128 a[136:139], v3 offset:49152
    v_mfma_f32_16x16x32_bf16 a[108:111], v[124:127], a[148:151], a[108:111]
    v_cvt_pk_bf16_f32 v71, v50, v51
    v_mfma_f32_16x16x32_bf16 a[108:111], v[120:123], a[144:147], a[108:111]
    s_add_u32 s29, s29, 0x2000
    v_exp_f32 v52, v52
    ds_read_b128 a[140:143], v4 offset:49152
    v_mfma_f32_16x16x32_bf16 a[112:115], v[96:99], a[152:155], a[112:115]
    buffer_load_dwordx4 v13, s[16:19], s29 offen offset:0 nt lds
    v_mfma_f32_16x16x32_bf16 a[112:115], v[100:103], a[156:159], a[112:115]
    v_exp_f32 v53, v53
    v_mfma_f32_16x16x32_bf16 a[116:119], v[108:111], a[156:159], a[116:119]
    v_cvt_pk_bf16_f32 v78, v52, v53
    v_mfma_f32_16x16x32_bf16 a[116:119], v[104:107], a[152:155], a[116:119]
    v_exp_f32 v54, v54
    v_mfma_f32_16x16x32_bf16 a[120:123], v[112:115], a[152:155], a[120:123]
    buffer_load_dwordx4 v14, s[16:19], s29 offen offset:1024 nt lds
    v_mfma_f32_16x16x32_bf16 a[120:123], v[116:119], a[156:159], a[120:123]
    v_exp_f32 v55, v55
    v_mfma_f32_16x16x32_bf16 a[124:127], v[124:127], a[156:159], a[124:127]
    v_cvt_pk_bf16_f32 v79, v54, v55
    v_mfma_f32_16x16x32_bf16 a[124:127], v[120:123], a[152:155], a[124:127]
    s_waitcnt lgkmcnt(0)
    v_mfma_f32_16x16x32_bf16 v[32:35], a[128:131], v[160:163], v[128:131]
    ds_read_b64_tr_b16 a[144:145], v5 offset:32768
    ds_read_b64_tr_b16 a[146:147], v5 offset:36864
    v_mfma_f32_16x16x32_bf16 v[32:35], a[132:135], v[164:167], v[32:35]
    v_exp_f32 v56, v56
    v_mfma_f32_16x16x32_bf16 v[32:35], a[136:139], v[168:171], v[32:35]
    ds_read_b64_tr_b16 a[148:149], v5 offset:40960
    ds_read_b64_tr_b16 a[150:151], v5 offset:45056
    v_mfma_f32_16x16x32_bf16 v[32:35], a[140:143], v[172:175], v[32:35]
    v_exp_f32 v57, v57
    v_mfma_f32_16x16x32_bf16 v[36:39], a[140:143], v[188:191], v[132:135]
    ds_read_b64_tr_b16 a[152:153], v6 offset:32768
    ds_read_b64_tr_b16 a[154:155], v6 offset:36864
    v_mfma_f32_16x16x32_bf16 v[36:39], a[136:139], v[184:187], v[36:39]
    v_exp_f32 v58, v58
    v_mfma_f32_16x16x32_bf16 v[36:39], a[132:135], v[180:183], v[36:39]
    ds_read_b64_tr_b16 a[156:157], v6 offset:40960
    ds_read_b64_tr_b16 a[158:159], v6 offset:45056
    v_mfma_f32_16x16x32_bf16 v[36:39], a[128:131], v[176:179], v[36:39]
    v_exp_f32 v59, v59
    v_mfma_f32_16x16x32_bf16 v[40:43], a[128:131], v[192:195], v[136:139]
    v_cvt_pk_bf16_f32 v86, v56, v57
    v_cvt_pk_bf16_f32 v87, v58, v59
    v_mfma_f32_16x16x32_bf16 v[40:43], a[132:135], v[196:199], v[40:43]
    v_exp_f32 v60, v60
    v_mfma_f32_16x16x32_bf16 v[40:43], a[136:139], v[200:203], v[40:43]
    v_mfma_f32_16x16x32_bf16 v[40:43], a[140:143], v[204:207], v[40:43]
    v_exp_f32 v61, v61
    v_mfma_f32_16x16x32_bf16 v[44:47], a[140:143], v[220:223], v[140:143]
    v_cvt_pk_bf16_f32 v94, v60, v61
    v_mfma_f32_16x16x32_bf16 v[44:47], a[136:139], v[216:219], v[44:47]
    v_exp_f32 v62, v62
    v_mfma_f32_16x16x32_bf16 v[44:47], a[132:135], v[212:215], v[44:47]
    v_mfma_f32_16x16x32_bf16 v[44:47], a[128:131], v[208:211], v[44:47]
    v_exp_f32 v63, v63
    v_mfma_f32_16x16x32_bf16 v[144:147], v[64:67], a[160:163], v[144:147]
    v_cvt_pk_bf16_f32 v95, v62, v63
    v_mfma_f32_16x16x32_bf16 v[144:147], v[68:71], a[160:163], v[144:147]
    s_waitcnt lgkmcnt(0)
    v_exp_f32 v32, v32
    v_mfma_f32_16x16x32_bf16 a[0:3], v[64:67], a[144:147], a[0:3]
    v_mfma_f32_16x16x32_bf16 a[0:3], v[68:71], a[148:151], a[0:3]
    v_exp_f32 v33, v33
    ds_read_b128 a[128:131], v1 offset:53248
    v_mfma_f32_16x16x32_bf16 a[4:7], v[76:79], a[148:151], a[4:7]
    v_cvt_pk_bf16_f32 v96, v32, v33
    v_mfma_f32_16x16x32_bf16 a[4:7], v[72:75], a[144:147], a[4:7]
    v_exp_f32 v34, v34
    ds_read_b128 a[132:135], v2 offset:53248
    v_mfma_f32_16x16x32_bf16 a[8:11], v[80:83], a[144:147], a[8:11]
    v_mfma_f32_16x16x32_bf16 a[8:11], v[84:87], a[148:151], a[8:11]
    v_exp_f32 v35, v35
    ds_read_b128 a[136:139], v3 offset:53248
    v_mfma_f32_16x16x32_bf16 a[12:15], v[92:95], a[148:151], a[12:15]
    v_cvt_pk_bf16_f32 v97, v34, v35
    v_mfma_f32_16x16x32_bf16 a[12:15], v[88:91], a[144:147], a[12:15]
    v_exp_f32 v36, v36
    ds_read_b128 a[140:143], v4 offset:53248
    v_mfma_f32_16x16x32_bf16 a[16:19], v[64:67], a[152:155], a[16:19]
    buffer_load_dwordx4 v15, s[16:19], s29 offen offset:2048 nt lds
    v_mfma_f32_16x16x32_bf16 a[16:19], v[68:71], a[156:159], a[16:19]
    v_exp_f32 v37, v37
    v_mfma_f32_16x16x32_bf16 a[20:23], v[76:79], a[156:159], a[20:23]
    v_cvt_pk_bf16_f32 v104, v36, v37
    v_mfma_f32_16x16x32_bf16 a[20:23], v[72:75], a[152:155], a[20:23]
    v_exp_f32 v38, v38
    v_mfma_f32_16x16x32_bf16 a[24:27], v[80:83], a[152:155], a[24:27]
    buffer_load_dwordx4 v16, s[16:19], s29 offen offset:3072 nt lds
    v_mfma_f32_16x16x32_bf16 a[24:27], v[84:87], a[156:159], a[24:27]
    v_exp_f32 v39, v39
    v_mfma_f32_16x16x32_bf16 a[28:31], v[92:95], a[156:159], a[28:31]
    v_cvt_pk_bf16_f32 v105, v38, v39
    v_mfma_f32_16x16x32_bf16 a[28:31], v[88:91], a[152:155], a[28:31]
    s_waitcnt lgkmcnt(0)
    v_mfma_f32_16x16x32_bf16 v[48:51], a[128:131], v[160:163], v[128:131]
    ds_read_b64_tr_b16 a[144:145], v7 offset:32768
    ds_read_b64_tr_b16 a[146:147], v7 offset:36864
    v_mfma_f32_16x16x32_bf16 v[48:51], a[132:135], v[164:167], v[48:51]
    v_exp_f32 v40, v40
    v_mfma_f32_16x16x32_bf16 v[48:51], a[136:139], v[168:171], v[48:51]
    ds_read_b64_tr_b16 a[148:149], v7 offset:40960
    ds_read_b64_tr_b16 a[150:151], v7 offset:45056
    v_mfma_f32_16x16x32_bf16 v[48:51], a[140:143], v[172:175], v[48:51]
    v_exp_f32 v41, v41
    v_mfma_f32_16x16x32_bf16 v[52:55], a[140:143], v[188:191], v[132:135]
    ds_read_b64_tr_b16 a[152:153], v8 offset:32768
    ds_read_b64_tr_b16 a[154:155], v8 offset:36864
    v_mfma_f32_16x16x32_bf16 v[52:55], a[136:139], v[184:187], v[52:55]
    v_exp_f32 v42, v42
    v_mfma_f32_16x16x32_bf16 v[52:55], a[132:135], v[180:183], v[52:55]
    ds_read_b64_tr_b16 a[156:157], v8 offset:40960
    ds_read_b64_tr_b16 a[158:159], v8 offset:45056
    v_mfma_f32_16x16x32_bf16 v[52:55], a[128:131], v[176:179], v[52:55]
    v_exp_f32 v43, v43
    v_mfma_f32_16x16x32_bf16 v[56:59], a[128:131], v[192:195], v[136:139]
    v_cvt_pk_bf16_f32 v112, v40, v41
    v_cvt_pk_bf16_f32 v113, v42, v43
    v_mfma_f32_16x16x32_bf16 v[56:59], a[132:135], v[196:199], v[56:59]
    v_exp_f32 v44, v44
    v_mfma_f32_16x16x32_bf16 v[56:59], a[136:139], v[200:203], v[56:59]
    v_mfma_f32_16x16x32_bf16 v[56:59], a[140:143], v[204:207], v[56:59]
    v_exp_f32 v45, v45
    v_mfma_f32_16x16x32_bf16 v[60:63], a[140:143], v[220:223], v[140:143]
    v_cvt_pk_bf16_f32 v120, v44, v45
    v_mfma_f32_16x16x32_bf16 v[60:63], a[136:139], v[216:219], v[60:63]
    v_exp_f32 v46, v46
    v_mfma_f32_16x16x32_bf16 v[60:63], a[132:135], v[212:215], v[60:63]
    v_mfma_f32_16x16x32_bf16 v[60:63], a[128:131], v[208:211], v[60:63]
    v_exp_f32 v47, v47
    v_mfma_f32_16x16x32_bf16 v[144:147], v[72:75], a[164:167], v[144:147]
    v_cvt_pk_bf16_f32 v121, v46, v47
    v_mfma_f32_16x16x32_bf16 v[144:147], v[76:79], a[164:167], v[144:147]
    s_waitcnt lgkmcnt(0)
    v_exp_f32 v48, v48
    v_mfma_f32_16x16x32_bf16 a[32:35], v[64:67], a[144:147], a[32:35]
    v_mfma_f32_16x16x32_bf16 a[32:35], v[68:71], a[148:151], a[32:35]
    v_exp_f32 v49, v49
    ds_read_b128 a[128:131], v1 offset:57344
    v_mfma_f32_16x16x32_bf16 a[36:39], v[76:79], a[148:151], a[36:39]
    v_cvt_pk_bf16_f32 v98, v48, v49
    v_mfma_f32_16x16x32_bf16 a[36:39], v[72:75], a[144:147], a[36:39]
    v_exp_f32 v50, v50
    ds_read_b128 a[132:135], v2 offset:57344
    v_mfma_f32_16x16x32_bf16 a[40:43], v[80:83], a[144:147], a[40:43]
    v_mfma_f32_16x16x32_bf16 a[40:43], v[84:87], a[148:151], a[40:43]
    s_mov_b32 m0, s53
    v_exp_f32 v51, v51
    ds_read_b128 a[136:139], v3 offset:57344
    v_mfma_f32_16x16x32_bf16 a[44:47], v[92:95], a[148:151], a[44:47]
    v_cvt_pk_bf16_f32 v99, v50, v51
    v_mfma_f32_16x16x32_bf16 a[44:47], v[88:91], a[144:147], a[44:47]
    s_add_u32 s29, s29, 0x2000
    v_exp_f32 v52, v52
    ds_read_b128 a[140:143], v4 offset:57344
    v_mfma_f32_16x16x32_bf16 a[48:51], v[64:67], a[152:155], a[48:51]
    buffer_load_dwordx4 v13, s[16:19], s29 offen offset:0 nt lds
    v_mfma_f32_16x16x32_bf16 a[48:51], v[68:71], a[156:159], a[48:51]
    v_exp_f32 v53, v53
    v_mfma_f32_16x16x32_bf16 a[52:55], v[76:79], a[156:159], a[52:55]
    v_cvt_pk_bf16_f32 v106, v52, v53
    v_mfma_f32_16x16x32_bf16 a[52:55], v[72:75], a[152:155], a[52:55]
    v_exp_f32 v54, v54
    v_mfma_f32_16x16x32_bf16 a[56:59], v[80:83], a[152:155], a[56:59]
    buffer_load_dwordx4 v14, s[16:19], s29 offen offset:1024 nt lds
    v_mfma_f32_16x16x32_bf16 a[56:59], v[84:87], a[156:159], a[56:59]
    v_exp_f32 v55, v55
    v_mfma_f32_16x16x32_bf16 a[60:63], v[92:95], a[156:159], a[60:63]
    v_cvt_pk_bf16_f32 v107, v54, v55
    v_mfma_f32_16x16x32_bf16 a[60:63], v[88:91], a[152:155], a[60:63]
    s_waitcnt lgkmcnt(0)
    v_mfma_f32_16x16x32_bf16 v[32:35], a[128:131], v[160:163], v[128:131]
    ds_read_b64_tr_b16 a[144:145], v9 offset:32768
    ds_read_b64_tr_b16 a[146:147], v9 offset:36864
    v_mfma_f32_16x16x32_bf16 v[32:35], a[132:135], v[164:167], v[32:35]
    v_exp_f32 v56, v56
    v_mfma_f32_16x16x32_bf16 v[32:35], a[136:139], v[168:171], v[32:35]
    ds_read_b64_tr_b16 a[148:149], v9 offset:40960
    ds_read_b64_tr_b16 a[150:151], v9 offset:45056
    v_mfma_f32_16x16x32_bf16 v[32:35], a[140:143], v[172:175], v[32:35]
    v_exp_f32 v57, v57
    v_mfma_f32_16x16x32_bf16 v[36:39], a[140:143], v[188:191], v[132:135]
    ds_read_b64_tr_b16 a[152:153], v10 offset:32768
    ds_read_b64_tr_b16 a[154:155], v10 offset:36864
    v_mfma_f32_16x16x32_bf16 v[36:39], a[136:139], v[184:187], v[36:39]
    v_exp_f32 v58, v58
    v_mfma_f32_16x16x32_bf16 v[36:39], a[132:135], v[180:183], v[36:39]
    ds_read_b64_tr_b16 a[156:157], v10 offset:40960
    ds_read_b64_tr_b16 a[158:159], v10 offset:45056
    v_mfma_f32_16x16x32_bf16 v[36:39], a[128:131], v[176:179], v[36:39]
    v_exp_f32 v59, v59
    v_mfma_f32_16x16x32_bf16 v[40:43], a[128:131], v[192:195], v[136:139]
    v_cvt_pk_bf16_f32 v114, v56, v57
    v_cvt_pk_bf16_f32 v115, v58, v59
    v_mfma_f32_16x16x32_bf16 v[40:43], a[132:135], v[196:199], v[40:43]
    v_exp_f32 v60, v60
    v_mfma_f32_16x16x32_bf16 v[40:43], a[136:139], v[200:203], v[40:43]
    v_mfma_f32_16x16x32_bf16 v[40:43], a[140:143], v[204:207], v[40:43]
    v_exp_f32 v61, v61
    v_mfma_f32_16x16x32_bf16 v[44:47], a[140:143], v[220:223], v[140:143]
    v_cvt_pk_bf16_f32 v122, v60, v61
    v_mfma_f32_16x16x32_bf16 v[44:47], a[136:139], v[216:219], v[44:47]
    v_exp_f32 v62, v62
    v_mfma_f32_16x16x32_bf16 v[44:47], a[132:135], v[212:215], v[44:47]
    v_mfma_f32_16x16x32_bf16 v[44:47], a[128:131], v[208:211], v[44:47]
    v_exp_f32 v63, v63
    v_mfma_f32_16x16x32_bf16 v[144:147], v[80:83], a[168:171], v[144:147]
    v_cvt_pk_bf16_f32 v123, v62, v63
    v_mfma_f32_16x16x32_bf16 v[144:147], v[84:87], a[168:171], v[144:147]
    s_waitcnt lgkmcnt(0)
    v_exp_f32 v32, v32
    v_mfma_f32_16x16x32_bf16 a[64:67], v[64:67], a[144:147], a[64:67]
    v_mfma_f32_16x16x32_bf16 a[64:67], v[68:71], a[148:151], a[64:67]
    v_exp_f32 v33, v33
    ds_read_b128 a[128:131], v1 offset:61440
    v_mfma_f32_16x16x32_bf16 a[68:71], v[76:79], a[148:151], a[68:71]
    v_cvt_pk_bf16_f32 v100, v32, v33
    v_mfma_f32_16x16x32_bf16 a[68:71], v[72:75], a[144:147], a[68:71]
    v_exp_f32 v34, v34
    ds_read_b128 a[132:135], v2 offset:61440
    v_mfma_f32_16x16x32_bf16 a[72:75], v[80:83], a[144:147], a[72:75]
    v_mfma_f32_16x16x32_bf16 a[72:75], v[84:87], a[148:151], a[72:75]
    v_exp_f32 v35, v35
    ds_read_b128 a[136:139], v3 offset:61440
    v_mfma_f32_16x16x32_bf16 a[76:79], v[92:95], a[148:151], a[76:79]
    v_cvt_pk_bf16_f32 v101, v34, v35
    v_mfma_f32_16x16x32_bf16 a[76:79], v[88:91], a[144:147], a[76:79]
    v_exp_f32 v36, v36
    ds_read_b128 a[140:143], v4 offset:61440
    v_mfma_f32_16x16x32_bf16 a[80:83], v[64:67], a[152:155], a[80:83]
    buffer_load_dwordx4 v15, s[16:19], s29 offen offset:2048 nt lds
    v_mfma_f32_16x16x32_bf16 a[80:83], v[68:71], a[156:159], a[80:83]
    v_exp_f32 v37, v37
    v_mfma_f32_16x16x32_bf16 a[84:87], v[76:79], a[156:159], a[84:87]
    v_cvt_pk_bf16_f32 v108, v36, v37
    v_mfma_f32_16x16x32_bf16 a[84:87], v[72:75], a[152:155], a[84:87]
    v_exp_f32 v38, v38
    v_mfma_f32_16x16x32_bf16 a[88:91], v[80:83], a[152:155], a[88:91]
    buffer_load_dwordx4 v16, s[16:19], s29 offen offset:3072 nt lds
    v_mfma_f32_16x16x32_bf16 a[88:91], v[84:87], a[156:159], a[88:91]
    v_exp_f32 v39, v39
    v_mfma_f32_16x16x32_bf16 a[92:95], v[92:95], a[156:159], a[92:95]
    v_cvt_pk_bf16_f32 v109, v38, v39
    v_mfma_f32_16x16x32_bf16 a[92:95], v[88:91], a[152:155], a[92:95]
    s_waitcnt lgkmcnt(0)
    v_mfma_f32_16x16x32_bf16 v[48:51], a[128:131], v[160:163], v[128:131]
    ds_read_b64_tr_b16 a[144:145], v11 offset:32768
    ds_read_b64_tr_b16 a[146:147], v11 offset:36864
    v_mfma_f32_16x16x32_bf16 v[48:51], a[132:135], v[164:167], v[48:51]
    v_exp_f32 v40, v40
    v_mfma_f32_16x16x32_bf16 v[48:51], a[136:139], v[168:171], v[48:51]
    ds_read_b64_tr_b16 a[148:149], v11 offset:40960
    ds_read_b64_tr_b16 a[150:151], v11 offset:45056
    v_mfma_f32_16x16x32_bf16 v[48:51], a[140:143], v[172:175], v[48:51]
    v_exp_f32 v41, v41
    v_mfma_f32_16x16x32_bf16 v[52:55], a[140:143], v[188:191], v[132:135]
    ds_read_b64_tr_b16 a[152:153], v12 offset:32768
    ds_read_b64_tr_b16 a[154:155], v12 offset:36864
    v_mfma_f32_16x16x32_bf16 v[52:55], a[136:139], v[184:187], v[52:55]
    v_exp_f32 v42, v42
    v_mfma_f32_16x16x32_bf16 v[52:55], a[132:135], v[180:183], v[52:55]
    ds_read_b64_tr_b16 a[156:157], v12 offset:40960
    ds_read_b64_tr_b16 a[158:159], v12 offset:45056
    v_mfma_f32_16x16x32_bf16 v[52:55], a[128:131], v[176:179], v[52:55]
    v_exp_f32 v43, v43
    v_mfma_f32_16x16x32_bf16 v[56:59], a[128:131], v[192:195], v[136:139]
    v_cvt_pk_bf16_f32 v116, v40, v41
    v_cvt_pk_bf16_f32 v117, v42, v43
    v_mfma_f32_16x16x32_bf16 v[56:59], a[132:135], v[196:199], v[56:59]
    v_exp_f32 v44, v44
    v_mfma_f32_16x16x32_bf16 v[56:59], a[136:139], v[200:203], v[56:59]
    v_mfma_f32_16x16x32_bf16 v[56:59], a[140:143], v[204:207], v[56:59]
    v_exp_f32 v45, v45
    v_mfma_f32_16x16x32_bf16 v[60:63], a[140:143], v[220:223], v[140:143]
    v_cvt_pk_bf16_f32 v124, v44, v45
    v_mfma_f32_16x16x32_bf16 v[60:63], a[136:139], v[216:219], v[60:63]
    v_exp_f32 v46, v46
    v_mfma_f32_16x16x32_bf16 v[60:63], a[132:135], v[212:215], v[60:63]
    v_mfma_f32_16x16x32_bf16 v[60:63], a[128:131], v[208:211], v[60:63]
    v_exp_f32 v47, v47
    v_mfma_f32_16x16x32_bf16 v[144:147], v[88:91], a[172:175], v[144:147]
    v_cvt_pk_bf16_f32 v125, v46, v47
    v_mfma_f32_16x16x32_bf16 v[144:147], v[92:95], a[172:175], v[144:147]
    s_waitcnt vmcnt(16) lgkmcnt(0)
    v_exp_f32 v48, v48
    v_mfma_f32_16x16x32_bf16 a[96:99], v[64:67], a[144:147], a[96:99]
    s_barrier
    v_mfma_f32_16x16x32_bf16 a[96:99], v[68:71], a[148:151], a[96:99]
    v_exp_f32 v49, v49
    ds_read_b128 a[128:131], v1 offset:0
    v_mfma_f32_16x16x32_bf16 a[100:103], v[76:79], a[148:151], a[100:103]
    v_cvt_pk_bf16_f32 v102, v48, v49
    v_mfma_f32_16x16x32_bf16 a[100:103], v[72:75], a[144:147], a[100:103]
    v_exp_f32 v50, v50
    ds_read_b128 a[132:135], v2 offset:0
    v_mfma_f32_16x16x32_bf16 a[104:107], v[80:83], a[144:147], a[104:107]
    v_mfma_f32_16x16x32_bf16 a[104:107], v[84:87], a[148:151], a[104:107]
    s_mov_b32 m0, s54
    v_exp_f32 v51, v51
    ds_read_b128 a[136:139], v3 offset:0
    v_mfma_f32_16x16x32_bf16 a[108:111], v[92:95], a[148:151], a[108:111]
    v_cvt_pk_bf16_f32 v103, v50, v51
    v_mfma_f32_16x16x32_bf16 a[108:111], v[88:91], a[144:147], a[108:111]
    s_add_u32 s29, s29, 0x2000
    v_exp_f32 v52, v52
    ds_read_b128 a[140:143], v4 offset:0
    v_mfma_f32_16x16x32_bf16 a[112:115], v[64:67], a[152:155], a[112:115]
    buffer_load_dwordx4 v13, s[16:19], s29 offen offset:0 nt lds
    v_mfma_f32_16x16x32_bf16 a[112:115], v[68:71], a[156:159], a[112:115]
    v_exp_f32 v53, v53
    v_mfma_f32_16x16x32_bf16 a[116:119], v[76:79], a[156:159], a[116:119]
    v_cvt_pk_bf16_f32 v110, v52, v53
    v_mfma_f32_16x16x32_bf16 a[116:119], v[72:75], a[152:155], a[116:119]
    v_exp_f32 v54, v54
    v_mfma_f32_16x16x32_bf16 a[120:123], v[80:83], a[152:155], a[120:123]
    buffer_load_dwordx4 v14, s[16:19], s29 offen offset:1024 nt lds
    v_mfma_f32_16x16x32_bf16 a[120:123], v[84:87], a[156:159], a[120:123]
    v_exp_f32 v55, v55
    v_mfma_f32_16x16x32_bf16 a[124:127], v[92:95], a[156:159], a[124:127]
    v_cvt_pk_bf16_f32 v111, v54, v55
    v_mfma_f32_16x16x32_bf16 a[124:127], v[88:91], a[152:155], a[124:127]
    s_waitcnt lgkmcnt(0)
    s_sub_u32 s31, s31, 1
    s_cmp_gt_u32 s31, 1
    s_cbranch_scc1 L_loopB
    v_mfma_f32_16x16x32_bf16 v[32:35], a[128:131], v[160:163], v[128:131]
    ds_read_b64_tr_b16 a[144:145], v5 offset:49152
    ds_read_b64_tr_b16 a[146:147], v5 offset:53248
    v_mfma_f32_16x16x32_bf16 v[32:35], a[132:135], v[164:167], v[32:35]
    v_exp_f32 v56, v56
    v_mfma_f32_16x16x32_bf16 v[32:35], a[136:139], v[168:171], v[32:35]
    ds_read_b64_tr_b16 a[148:149], v5 offset:57344
    ds_read_b64_tr_b16 a[150:151], v5 offset:61440
    v_mfma_f32_16x16x32_bf16 v[32:35], a[140:143], v[172:175], v[32:35]
    v_exp_f32 v57, v57
    v_mfma_f32_16x16x32_bf16 v[36:39], a[140:143], v[188:191], v[132:135]
    ds_read_b64_tr_b16 a[152:153], v6 offset:49152
    ds_read_b64_tr_b16 a[154:155], v6 offset:53248
    v_mfma_f32_16x16x32_bf16 v[36:39], a[136:139], v[184:187], v[36:39]
    v_exp_f32 v58, v58
    v_mfma_f32_16x16x32_bf16 v[36:39], a[132:135], v[180:183], v[36:39]
    ds_read_b64_tr_b16 a[156:157], v6 offset:57344
    ds_read_b64_tr_b16 a[158:159], v6 offset:61440
    v_mfma_f32_16x16x32_bf16 v[36:39], a[128:131], v[176:179], v[36:39]
    v_exp_f32 v59, v59
    v_mfma_f32_16x16x32_bf16 v[40:43], a[128:131], v[192:195], v[136:139]
    v_cvt_pk_bf16_f32 v118, v56, v57
    v_cvt_pk_bf16_f32 v119, v58, v59
    v_mfma_f32_16x16x32_bf16 v[40:43], a[132:135], v[196:199], v[40:43]
    v_exp_f32 v60, v60
    v_mfma_f32_16x16x32_bf16 v[40:43], a[136:139], v[200:203], v[40:43]
    v_mfma_f32_16x16x32_bf16 v[40:43], a[140:143], v[204:207], v[40:43]
    v_exp_f32 v61, v61
    v_mfma_f32_16x16x32_bf16 v[44:47], a[140:143], v[220:223], v[140:143]
    v_cvt_pk_bf16_f32 v126, v60, v61
    v_mfma_f32_16x16x32_bf16 v[44:47], a[136:139], v[216:219], v[44:47]
    v_exp_f32 v62, v62
    v_mfma_f32_16x16x32_bf16 v[44:47], a[132:135], v[212:215], v[44:47]
    v_mfma_f32_16x16x32_bf16 v[44:47], a[128:131], v[208:211], v[44:47]
    v_exp_f32 v63, v63
    v_mfma_f32_16x16x32_bf16 v[144:147], v[96:99], a[160:163], v[144:147]
    v_cvt_pk_bf16_f32 v127, v62, v63
    v_mfma_f32_16x16x32_bf16 v[144:147], v[100:103], a[160:163], v[144:147]
    s_waitcnt lgkmcnt(0)
    v_exp_f32 v32, v32
    v_mfma_f32_16x16x32_bf16 a[0:3], v[96:99], a[144:147], a[0:3]
    ds_read_b128 a[128:131], v1 offset:4096
    v_mfma_f32_16x16x32_bf16 a[0:3], v[100:103], a[148:151], a[0:3]
    v_exp_f32 v33, v33
    v_mfma_f32_16x16x32_bf16 a[4:7], v[108:111], a[148:151], a[4:7]
    ds_read_b128 a[132:135], v2 offset:4096
    v_cvt_pk_bf16_f32 v64, v32, v33
    v_mfma_f32_16x16x32_bf16 a[4:7], v[104:107], a[144:147], a[4:7]
    v_exp_f32 v34, v34
    v_mfma_f32_16x16x32_bf16 a[8:11], v[112:115], a[144:147], a[8:11]
    ds_read_b128 a[136:139], v3 offset:4096
    v_mfma_f32_16x16x32_bf16 a[8:11], v[116:119], a[148:151], a[8:11]
    v_exp_f32 v35, v35
    v_mfma_f32_16x16x32_bf16 a[12:15], v[124:127], a[148:151], a[12:15]
    ds_read_b128 a[140:143], v4 offset:4096
    v_cvt_pk_bf16_f32 v65, v34, v35
    v_mfma_f32_16x16x32_bf16 a[12:15], v[120:123], a[144:147], a[12:15]
    v_exp_f32 v36, v36
    v_mfma_f32_16x16x32_bf16 a[16:19], v[96:99], a[152:155], a[16:19]
    buffer_load_dwordx4 v15, s[16:19], s29 offen offset:2048 nt lds
    v_mfma_f32_16x16x32_bf16 a[16:19], v[100:103], a[156:159], a[16:19]
    v_exp_f32 v37, v37
    v_mfma_f32_16x16x32_bf16 a[20:23], v[108:111], a[156:159], a[20:23]
    v_cvt_pk_bf16_f32 v72, v36, v37
    v_mfma_f32_16x16x32_bf16 a[20:23], v[104:107], a[152:155], a[20:23]
    v_exp_f32 v38, v38
    v_mfma_f32_16x16x32_bf16 a[24:27], v[112:115], a[152:155], a[24:27]
    buffer_load_dwordx4 v16, s[16:19], s29 offen offset:3072 nt lds
    v_mfma_f32_16x16x32_bf16 a[24:27], v[116:119], a[156:159], a[24:27]
    v_exp_f32 v39, v39
    v_mfma_f32_16x16x32_bf16 a[28:31], v[124:127], a[156:159], a[28:31]
    v_cvt_pk_bf16_f32 v73, v38, v39
    v_mfma_f32_16x16x32_bf16 a[28:31], v[120:123], a[152:155], a[28:31]
    s_waitcnt lgkmcnt(0)
    v_mfma_f32_16x16x32_bf16 v[48:51], a[128:131], v[160:163], v[128:131]
    ds_read_b64_tr_b16 a[144:145], v7 offset:49152
    ds_read_b64_tr_b16 a[146:147], v7 offset:53248
    v_mfma_f32_16x16x32_bf16 v[48:51], a[132:135], v[164:167], v[48:51]
    v_exp_f32 v40, v40
    v_mfma_f32_16x16x32_bf16 v[48:51], a[136:139], v[168:171], v[48:51]
    ds_read_b64_tr_b16 a[148:149], v7 offset:57344
    ds_read_b64_tr_b16 a[150:151], v7 offset:61440
    v_mfma_f32_16x16x32_bf16 v[48:51], a[140:143], v[172:175], v[48:51]
    v_exp_f32 v41, v41
    v_mfma_f32_16x16x32_bf16 v[52:55], a[140:143], v[188:191], v[132:135]
    ds_read_b64_tr_b16 a[152:153], v8 offset:49152
    ds_read_b64_tr_b16 a[154:155], v8 offset:53248
    v_mfma_f32_16x16x32_bf16 v[52:55], a[136:139], v[184:187], v[52:55]
    v_exp_f32 v42, v42
    v_mfma_f32_16x16x32_bf16 v[52:55], a[132:135], v[180:183], v[52:55]
    ds_read_b64_tr_b16 a[156:157], v8 offset:57344
    ds_read_b64_tr_b16 a[158:159], v8 offset:61440
    v_mfma_f32_16x16x32_bf16 v[52:55], a[128:131], v[176:179], v[52:55]
    v_exp_f32 v43, v43
    v_mfma_f32_16x16x32_bf16 v[56:59], a[128:131], v[192:195], v[136:139]
    v_cvt_pk_bf16_f32 v80, v40, v41
    v_cvt_pk_bf16_f32 v81, v42, v43
    v_mfma_f32_16x16x32_bf16 v[56:59], a[132:135], v[196:199], v[56:59]
    v_exp_f32 v44, v44
    v_mfma_f32_16x16x32_bf16 v[56:59], a[136:139], v[200:203], v[56:59]
    v_mfma_f32_16x16x32_bf16 v[56:59], a[140:143], v[204:207], v[56:59]
    v_exp_f32 v45, v45
    v_mfma_f32_16x16x32_bf16 v[60:63], a[140:143], v[220:223], v[140:143]
    v_cvt_pk_bf16_f32 v88, v44, v45
    v_mfma_f32_16x16x32_bf16 v[60:63], a[136:139], v[216:219], v[60:63]
    v_exp_f32 v46, v46
    v_mfma_f32_16x16x32_bf16 v[60:63], a[132:135], v[212:215], v[60:63]
    v_mfma_f32_16x16x32_bf16 v[60:63], a[128:131], v[208:211], v[60:63]
    v_exp_f32 v47, v47
    v_mfma_f32_16x16x32_bf16 v[144:147], v[104:107], a[164:167], v[144:147]
    v_cvt_pk_bf16_f32 v89, v46, v47
    v_mfma_f32_16x16x32_bf16 v[144:147], v[108:111], a[164:167], v[144:147]
    s_waitcnt lgkmcnt(0)
    v_exp_f32 v48, v48
    v_mfma_f32_16x16x32_bf16 a[32:35], v[96:99], a[144:147], a[32:35]
    ds_read_b128 a[128:131], v1 offset:8192
    v_mfma_f32_16x16x32_bf16 a[32:35], v[100:103], a[148:151], a[32:35]
    v_exp_f32 v49, v49
    v_mfma_f32_16x16x32_bf16 a[36:39], v[108:111], a[148:151], a[36:39]
    ds_read_b128 a[132:135], v2 offset:8192
    v_cvt_pk_bf16_f32 v66, v48, v49
    v_mfma_f32_16x16x32_bf16 a[36:39], v[104:107], a[144:147], a[36:39]
    v_exp_f32 v50, v50
    v_mfma_f32_16x16x32_bf16 a[40:43], v[112:115], a[144:147], a[40:43]
    ds_read_b128 a[136:139], v3 offset:8192
    v_mfma_f32_16x16x32_bf16 a[40:43], v[116:119], a[148:151], a[40:43]
    s_mov_b32 m0, s55
    v_exp_f32 v51, v51
    v_mfma_f32_16x16x32_bf16 a[44:47], v[124:127], a[148:151], a[44:47]
    ds_read_b128 a[140:143], v4 offset:8192
    v_cvt_pk_bf16_f32 v67, v50, v51
    v_mfma_f32_16x16x32_bf16 a[44:47], v[120:123], a[144:147], a[44:47]
    s_add_u32 s29, s29, 0x2000
    v_exp_f32 v52, v52
    v_mfma_f32_16x16x32_bf16 a[48:51], v[96:99], a[152:155], a[48:51]
    buffer_load_dwordx4 v13, s[16:19], s29 offen offset:0 nt lds
    v_mfma_f32_16x16x32_bf16 a[48:51], v[100:103], a[156:159], a[48:51]
    v_exp_f32 v53, v53
    v_mfma_f32_16x16x32_bf16 a[52:55], v[108:111], a[156:159], a[52:55]
    v_cvt_pk_bf16_f32 v74, v52, v53
    v_mfma_f32_16x16x32_bf16 a[52:55], v[104:107], a[152:155], a[52:55]
    v_exp_f32 v54, v54
    v_mfma_f32_16x16x32_bf16 a[56:59], v[112:115], a[152:155], a[56:59]
    buffer_load_dwordx4 v14, s[16:19], s29 offen offset:1024 nt lds
    v_mfma_f32_16x16x32_bf16 a[56:59], v[116:119], a[156:159], a[56:59]
    v_exp_f32 v55, v55
    v_mfma_f32_16x16x32_bf16 a[60:63], v[124:127], a[156:159], a[60:63]
    v_cvt_pk_bf16_f32 v75, v54, v55
    v_mfma_f32_16x16x32_bf16 a[60:63], v[120:123], a[152:155], a[60:63]
    s_waitcnt lgkmcnt(0)
    v_mfma_f32_16x16x32_bf16 v[32:35], a[128:131], v[160:163], v[128:131]
    ds_read_b64_tr_b16 a[144:145], v9 offset:49152
    ds_read_b64_tr_b16 a[146:147], v9 offset:53248
    v_mfma_f32_16x16x32_bf16 v[32:35], a[132:135], v[164:167], v[32:35]
    v_exp_f32 v56, v56
    v_mfma_f32_16x16x32_bf16 v[32:35], a[136:139], v[168:171], v[32:35]
    ds_read_b64_tr_b16 a[148:149], v9 offset:57344
    ds_read_b64_tr_b16 a[150:151], v9 offset:61440
    v_mfma_f32_16x16x32_bf16 v[32:35], a[140:143], v[172:175], v[32:35]
    v_exp_f32 v57, v57
    v_mfma_f32_16x16x32_bf16 v[36:39], a[140:143], v[188:191], v[132:135]
    ds_read_b64_tr_b16 a[152:153], v10 offset:49152
    ds_read_b64_tr_b16 a[154:155], v10 offset:53248
    v_mfma_f32_16x16x32_bf16 v[36:39], a[136:139], v[184:187], v[36:39]
    v_exp_f32 v58, v58
    v_mfma_f32_16x16x32_bf16 v[36:39], a[132:135], v[180:183], v[36:39]
    ds_read_b64_tr_b16 a[156:157], v10 offset:57344
    ds_read_b64_tr_b16 a[158:159], v10 offset:61440
    v_mfma_f32_16x16x32_bf16 v[36:39], a[128:131], v[176:179], v[36:39]
    v_exp_f32 v59, v59
    v_mfma_f32_16x16x32_bf16 v[40:43], a[128:131], v[192:195], v[136:139]
    v_cvt_pk_bf16_f32 v82, v56, v57
    v_cvt_pk_bf16_f32 v83, v58, v59
    v_mfma_f32_16x16x32_bf16 v[40:43], a[132:135], v[196:199], v[40:43]
    v_exp_f32 v60, v60
    v_mfma_f32_16x16x32_bf16 v[40:43], a[136:139], v[200:203], v[40:43]
    v_mfma_f32_16x16x32_bf16 v[40:43], a[140:143], v[204:207], v[40:43]
    v_exp_f32 v61, v61
    v_mfma_f32_16x16x32_bf16 v[44:47], a[140:143], v[220:223], v[140:143]
    v_cvt_pk_bf16_f32 v90, v60, v61
    v_mfma_f32_16x16x32_bf16 v[44:47], a[136:139], v[216:219], v[44:47]
    v_exp_f32 v62, v62
    v_mfma_f32_16x16x32_bf16 v[44:47], a[132:135], v[212:215], v[44:47]
    v_mfma_f32_16x16x32_bf16 v[44:47], a[128:131], v[208:211], v[44:47]
    v_exp_f32 v63, v63
    v_mfma_f32_16x16x32_bf16 v[144:147], v[112:115], a[168:171], v[144:147]
    v_cvt_pk_bf16_f32 v91, v62, v63
    v_mfma_f32_16x16x32_bf16 v[144:147], v[116:119], a[168:171], v[144:147]
    s_waitcnt lgkmcnt(0)
    v_exp_f32 v32, v32
    v_mfma_f32_16x16x32_bf16 a[64:67], v[96:99], a[144:147], a[64:67]
    ds_read_b128 a[128:131], v1 offset:12288
    v_mfma_f32_16x16x32_bf16 a[64:67], v[100:103], a[148:151], a[64:67]
    v_exp_f32 v33, v33
    v_mfma_f32_16x16x32_bf16 a[68:71], v[108:111], a[148:151], a[68:71]
    ds_read_b128 a[132:135], v2 offset:12288
    v_cvt_pk_bf16_f32 v68, v32, v33
    v_mfma_f32_16x16x32_bf16 a[68:71], v[104:107], a[144:147], a[68:71]
    v_exp_f32 v34, v34
    v_mfma_f32_16x16x32_bf16 a[72:75], v[112:115], a[144:147], a[72:75]
    ds_read_b128 a[136:139], v3 offset:12288
    v_mfma_f32_16x16x32_bf16 a[72:75], v[116:119], a[148:151], a[72:75]
    v_exp_f32 v35, v35
    v_mfma_f32_16x16x32_bf16 a[76:79], v[124:127], a[148:151], a[76:79]
    ds_read_b128 a[140:143], v4 offset:12288
    v_cvt_pk_bf16_f32 v69, v34, v35
    v_mfma_f32_16x16x32_bf16 a[76:79], v[120:123], a[144:147], a[76:79]
    v_exp_f32 v36, v36
    v_mfma_f32_16x16x32_bf16 a[80:83], v[96:99], a[152:155], a[80:83]
    buffer_load_dwordx4 v15, s[16:19], s29 offen offset:2048 nt lds
    v_mfma_f32_16x16x32_bf16 a[80:83], v[100:103], a[156:159], a[80:83]
    v_exp_f32 v37, v37
    v_mfma_f32_16x16x32_bf16 a[84:87], v[108:111], a[156:159], a[84:87]
    v_cvt_pk_bf16_f32 v76, v36, v37
    v_mfma_f32_16x16x32_bf16 a[84:87], v[104:107], a[152:155], a[84:87]
    v_exp_f32 v38, v38
    v_mfma_f32_16x16x32_bf16 a[88:91], v[112:115], a[152:155], a[88:91]
    buffer_load_dwordx4 v16, s[16:19], s29 offen offset:3072 nt lds
    v_mfma_f32_16x16x32_bf16 a[88:91], v[116:119], a[156:159], a[88:91]
    v_exp_f32 v39, v39
    v_mfma_f32_16x16x32_bf16 a[92:95], v[124:127], a[156:159], a[92:95]
    v_cvt_pk_bf16_f32 v77, v38, v39
    v_mfma_f32_16x16x32_bf16 a[92:95], v[120:123], a[152:155], a[92:95]
    s_waitcnt lgkmcnt(0)
    v_mfma_f32_16x16x32_bf16 v[48:51], a[128:131], v[160:163], v[128:131]
    ds_read_b64_tr_b16 a[144:145], v11 offset:49152
    ds_read_b64_tr_b16 a[146:147], v11 offset:53248
    v_mfma_f32_16x16x32_bf16 v[48:51], a[132:135], v[164:167], v[48:51]
    v_exp_f32 v40, v40
    v_mfma_f32_16x16x32_bf16 v[48:51], a[136:139], v[168:171], v[48:51]
    ds_read_b64_tr_b16 a[148:149], v11 offset:57344
    ds_read_b64_tr_b16 a[150:151], v11 offset:61440
    v_mfma_f32_16x16x32_bf16 v[48:51], a[140:143], v[172:175], v[48:51]
    v_exp_f32 v41, v41
    v_mfma_f32_16x16x32_bf16 v[52:55], a[140:143], v[188:191], v[132:135]
    ds_read_b64_tr_b16 a[152:153], v12 offset:49152
    ds_read_b64_tr_b16 a[154:155], v12 offset:53248
    v_mfma_f32_16x16x32_bf16 v[52:55], a[136:139], v[184:187], v[52:55]
    v_exp_f32 v42, v42
    v_mfma_f32_16x16x32_bf16 v[52:55], a[132:135], v[180:183], v[52:55]
    ds_read_b64_tr_b16 a[156:157], v12 offset:57344
    ds_read_b64_tr_b16 a[158:159], v12 offset:61440
    v_mfma_f32_16x16x32_bf16 v[52:55], a[128:131], v[176:179], v[52:55]
    v_exp_f32 v43, v43
    v_mfma_f32_16x16x32_bf16 v[56:59], a[128:131], v[192:195], v[136:139]
    v_cvt_pk_bf16_f32 v84, v40, v41
    v_cvt_pk_bf16_f32 v85, v42, v43
    v_mfma_f32_16x16x32_bf16 v[56:59], a[132:135], v[196:199], v[56:59]
    v_exp_f32 v44, v44
    v_mfma_f32_16x16x32_bf16 v[56:59], a[136:139], v[200:203], v[56:59]
    v_mfma_f32_16x16x32_bf16 v[56:59], a[140:143], v[204:207], v[56:59]
    v_exp_f32 v45, v45
    v_mfma_f32_16x16x32_bf16 v[60:63], a[140:143], v[220:223], v[140:143]
    v_cvt_pk_bf16_f32 v92, v44, v45
    v_mfma_f32_16x16x32_bf16 v[60:63], a[136:139], v[216:219], v[60:63]
    v_exp_f32 v46, v46
    v_mfma_f32_16x16x32_bf16 v[60:63], a[132:135], v[212:215], v[60:63]
    v_mfma_f32_16x16x32_bf16 v[60:63], a[128:131], v[208:211], v[60:63]
    v_exp_f32 v47, v47
    v_mfma_f32_16x16x32_bf16 v[144:147], v[120:123], a[172:175], v[144:147]
    v_cvt_pk_bf16_f32 v93, v46, v47
    v_mfma_f32_16x16x32_bf16 v[144:147], v[124:127], a[172:175], v[144:147]
    s_waitcnt vmcnt(16) lgkmcnt(0)
    v_exp_f32 v48, v48
    v_mfma_f32_16x16x32_bf16 a[96:99], v[96:99], a[144:147], a[96:99]
    s_barrier
    ds_read_b128 a[128:131], v1 offset:16384
    v_mfma_f32_16x16x32_bf16 a[96:99], v[100:103], a[148:151], a[96:99]
    v_exp_f32 v49, v49
    v_mfma_f32_16x16x32_bf16 a[100:103], v[108:111], a[148:151], a[100:103]
    ds_read_b128 a[132:135], v2 offset:16384
    v_cvt_pk_bf16_f32 v70, v48, v49
    v_mfma_f32_16x16x32_bf16 a[100:103], v[104:107], a[144:147], a[100:103]
    v_exp_f32 v50, v50
    v_mfma_f32_16x16x32_bf16 a[104:107], v[112:115], a[144:147], a[104:107]
    ds_read_b128 a[136:139], v3 offset:16384
    v_mfma_f32_16x16x32_bf16 a[104:107], v[116:119], a[148:151], a[104:107]
    s_mov_b32 m0, s48
    v_exp_f32 v51, v51
    v_mfma_f32_16x16x32_bf16 a[108:111], v[124:127], a[148:151], a[108:111]
    ds_read_b128 a[140:143], v4 offset:16384
    v_cvt_pk_bf16_f32 v71, v50, v51
    v_mfma_f32_16x16x32_bf16 a[108:111], v[120:123], a[144:147], a[108:111]
    s_add_u32 s29, s29, 0x2000
    v_exp_f32 v52, v52
    v_mfma_f32_16x16x32_bf16 a[112:115], v[96:99], a[152:155], a[112:115]
    buffer_load_dwordx4 v13, s[16:19], s29 offen offset:0 nt lds
    v_mfma_f32_16x16x32_bf16 a[112:115], v[100:103], a[156:159], a[112:115]
    v_exp_f32 v53, v53
    v_mfma_f32_16x16x32_bf16 a[116:119], v[108:111], a[156:159], a[116:119]
    v_cvt_pk_bf16_f32 v78, v52, v53
    v_mfma_f32_16x16x32_bf16 a[116:119], v[104:107], a[152:155], a[116:119]
    v_exp_f32 v54, v54
    v_mfma_f32_16x16x32_bf16 a[120:123], v[112:115], a[152:155], a[120:123]
    buffer_load_dwordx4 v14, s[16:19], s29 offen offset:1024 nt lds
    v_mfma_f32_16x16x32_bf16 a[120:123], v[116:119], a[156:159], a[120:123]
    v_exp_f32 v55, v55
    v_mfma_f32_16x16x32_bf16 a[124:127], v[124:127], a[156:159], a[124:127]
    v_cvt_pk_bf16_f32 v79, v54, v55
    v_mfma_f32_16x16x32_bf16 a[124:127], v[120:123], a[152:155], a[124:127]
    s_waitcnt lgkmcnt(0)
    v_mfma_f32_16x16x32_bf16 v[32:35], a[128:131], v[160:163], v[128:131]
    ds_read_b64_tr_b16 a[144:145], v5 offset:0
    ds_read_b64_tr_b16 a[146:147], v5 offset:4096
    v_mfma_f32_16x16x32_bf16 v[32:35], a[132:135], v[164:167], v[32:35]
    v_exp_f32 v56, v56
    v_mfma_f32_16x16x32_bf16 v[32:35], a[136:139], v[168:171], v[32:35]
    ds_read_b64_tr_b16 a[148:149], v5 offset:8192
    ds_read_b64_tr_b16 a[150:151], v5 offset:12288
    v_mfma_f32_16x16x32_bf16 v[32:35], a[140:143], v[172:175], v[32:35]
    v_exp_f32 v57, v57
    v_mfma_f32_16x16x32_bf16 v[36:39], a[140:143], v[188:191], v[132:135]
    ds_read_b64_tr_b16 a[152:153], v6 offset:0
    ds_read_b64_tr_b16 a[154:155], v6 offset:4096
    v_mfma_f32_16x16x32_bf16 v[36:39], a[136:139], v[184:187], v[36:39]
    v_exp_f32 v58, v58
    v_mfma_f32_16x16x32_bf16 v[36:39], a[132:135], v[180:183], v[36:39]
    ds_read_b64_tr_b16 a[156:157], v6 offset:8192
    ds_read_b64_tr_b16 a[158:159], v6 offset:12288
    v_mfma_f32_16x16x32_bf16 v[36:39], a[128:131], v[176:179], v[36:39]
    v_exp_f32 v59, v59
    v_mfma_f32_16x16x32_bf16 v[40:43], a[128:131], v[192:195], v[136:139]
    v_cvt_pk_bf16_f32 v86, v56, v57
    v_cvt_pk_bf16_f32 v87, v58, v59
    v_mfma_f32_16x16x32_bf16 v[40:43], a[132:135], v[196:199], v[40:43]
    v_exp_f32 v60, v60
    v_mfma_f32_16x16x32_bf16 v[40:43], a[136:139], v[200:203], v[40:43]
    v_mfma_f32_16x16x32_bf16 v[40:43], a[140:143], v[204:207], v[40:43]
    v_exp_f32 v61, v61
    v_mfma_f32_16x16x32_bf16 v[44:47], a[140:143], v[220:223], v[140:143]
    v_cvt_pk_bf16_f32 v94, v60, v61
    v_mfma_f32_16x16x32_bf16 v[44:47], a[136:139], v[216:219], v[44:47]
    v_exp_f32 v62, v62
    v_mfma_f32_16x16x32_bf16 v[44:47], a[132:135], v[212:215], v[44:47]
    v_mfma_f32_16x16x32_bf16 v[44:47], a[128:131], v[208:211], v[44:47]
    v_exp_f32 v63, v63
    v_mfma_f32_16x16x32_bf16 v[144:147], v[64:67], a[160:163], v[144:147]
    v_cvt_pk_bf16_f32 v95, v62, v63
    v_mfma_f32_16x16x32_bf16 v[144:147], v[68:71], a[160:163], v[144:147]
    s_waitcnt lgkmcnt(0)
    v_exp_f32 v32, v32
    v_mfma_f32_16x16x32_bf16 a[0:3], v[64:67], a[144:147], a[0:3]
    ds_read_b128 a[128:131], v1 offset:20480
    v_mfma_f32_16x16x32_bf16 a[0:3], v[68:71], a[148:151], a[0:3]
    v_exp_f32 v33, v33
    v_mfma_f32_16x16x32_bf16 a[4:7], v[76:79], a[148:151], a[4:7]
    ds_read_b128 a[132:135], v2 offset:20480
    v_cvt_pk_bf16_f32 v96, v32, v33
    v_mfma_f32_16x16x32_bf16 a[4:7], v[72:75], a[144:147], a[4:7]
    v_exp_f32 v34, v34
    v_mfma_f32_16x16x32_bf16 a[8:11], v[80:83], a[144:147], a[8:11]
    ds_read_b128 a[136:139], v3 offset:20480
    v_mfma_f32_16x16x32_bf16 a[8:11], v[84:87], a[148:151], a[8:11]
    v_exp_f32 v35, v35
    v_mfma_f32_16x16x32_bf16 a[12:15], v[92:95], a[148:151], a[12:15]
    ds_read_b128 a[140:143], v4 offset:20480
    v_cvt_pk_bf16_f32 v97, v34, v35
    v_mfma_f32_16x16x32_bf16 a[12:15], v[88:91], a[144:147], a[12:15]
    v_exp_f32 v36, v36
    v_mfma_f32_16x16x32_bf16 a[16:19], v[64:67], a[152:155], a[16:19]
    buffer_load_dwordx4 v15, s[16:19], s29 offen offset:2048 nt lds
    v_mfma_f32_16x16x32_bf16 a[16:19], v[68:71], a[156:159], a[16:19]
    v_exp_f32 v37, v37
    v_mfma_f32_16x16x32_bf16 a[20:23], v[76:79], a[156:159], a[20:23]
    v_cvt_pk_bf16_f32 v104, v36, v37
    v_mfma_f32_16x16x32_bf16 a[20:23], v[72:75], a[152:155], a[20:23]
    v_exp_f32 v38, v38
    v_mfma_f32_16x16x32_bf16 a[24:27], v[80:83], a[152:155], a[24:27]
    buffer_load_dwordx4 v16, s[16:19], s29 offen offset:3072 nt lds
    v_mfma_f32_16x16x32_bf16 a[24:27], v[84:87], a[156:159], a[24:27]
    v_exp_f32 v39, v39
    v_mfma_f32_16x16x32_bf16 a[28:31], v[92:95], a[156:159], a[28:31]
    v_cvt_pk_bf16_f32 v105, v38, v39
    v_mfma_f32_16x16x32_bf16 a[28:31], v[88:91], a[152:155], a[28:31]
    s_waitcnt lgkmcnt(0)
    v_mfma_f32_16x16x32_bf16 v[48:51], a[128:131], v[160:163], v[128:131]
    ds_read_b64_tr_b16 a[144:145], v7 offset:0
    ds_read_b64_tr_b16 a[146:147], v7 offset:4096
    v_mfma_f32_16x16x32_bf16 v[48:51], a[132:135], v[164:167], v[48:51]
    v_exp_f32 v40, v40
    v_mfma_f32_16x16x32_bf16 v[48:51], a[136:139], v[168:171], v[48:51]
    ds_read_b64_tr_b16 a[148:149], v7 offset:8192
    ds_read_b64_tr_b16 a[150:151], v7 offset:12288
    v_mfma_f32_16x16x32_bf16 v[48:51], a[140:143], v[172:175], v[48:51]
    v_exp_f32 v41, v41
    v_mfma_f32_16x16x32_bf16 v[52:55], a[140:143], v[188:191], v[132:135]
    ds_read_b64_tr_b16 a[152:153], v8 offset:0
    ds_read_b64_tr_b16 a[154:155], v8 offset:4096
    v_mfma_f32_16x16x32_bf16 v[52:55], a[136:139], v[184:187], v[52:55]
    v_exp_f32 v42, v42
    v_mfma_f32_16x16x32_bf16 v[52:55], a[132:135], v[180:183], v[52:55]
    ds_read_b64_tr_b16 a[156:157], v8 offset:8192
    ds_read_b64_tr_b16 a[158:159], v8 offset:12288
    v_mfma_f32_16x16x32_bf16 v[52:55], a[128:131], v[176:179], v[52:55]
    v_exp_f32 v43, v43
    v_mfma_f32_16x16x32_bf16 v[56:59], a[128:131], v[192:195], v[136:139]
    v_cvt_pk_bf16_f32 v112, v40, v41
    v_cvt_pk_bf16_f32 v113, v42, v43
    v_mfma_f32_16x16x32_bf16 v[56:59], a[132:135], v[196:199], v[56:59]
    v_exp_f32 v44, v44
    v_mfma_f32_16x16x32_bf16 v[56:59], a[136:139], v[200:203], v[56:59]
    v_mfma_f32_16x16x32_bf16 v[56:59], a[140:143], v[204:207], v[56:59]
    v_exp_f32 v45, v45
    v_mfma_f32_16x16x32_bf16 v[60:63], a[140:143], v[220:223], v[140:143]
    v_cvt_pk_bf16_f32 v120, v44, v45
    v_mfma_f32_16x16x32_bf16 v[60:63], a[136:139], v[216:219], v[60:63]
    v_exp_f32 v46, v46
    v_mfma_f32_16x16x32_bf16 v[60:63], a[132:135], v[212:215], v[60:63]
    v_mfma_f32_16x16x32_bf16 v[60:63], a[128:131], v[208:211], v[60:63]
    v_exp_f32 v47, v47
    v_mfma_f32_16x16x32_bf16 v[144:147], v[72:75], a[164:167], v[144:147]
    v_cvt_pk_bf16_f32 v121, v46, v47
    v_mfma_f32_16x16x32_bf16 v[144:147], v[76:79], a[164:167], v[144:147]
    s_waitcnt lgkmcnt(0)
    v_exp_f32 v48, v48
    v_mfma_f32_16x16x32_bf16 a[32:35], v[64:67], a[144:147], a[32:35]
    ds_read_b128 a[128:131], v1 offset:24576
    v_mfma_f32_16x16x32_bf16 a[32:35], v[68:71], a[148:151], a[32:35]
    v_exp_f32 v49, v49
    v_mfma_f32_16x16x32_bf16 a[36:39], v[76:79], a[148:151], a[36:39]
    ds_read_b128 a[132:135], v2 offset:24576
    v_cvt_pk_bf16_f32 v98, v48, v49
    v_mfma_f32_16x16x32_bf16 a[36:39], v[72:75], a[144:147], a[36:39]
    v_exp_f32 v50, v50
    v_mfma_f32_16x16x32_bf16 a[40:43], v[80:83], a[144:147], a[40:43]
    ds_read_b128 a[136:139], v3 offset:24576
    v_mfma_f32_16x16x32_bf16 a[40:43], v[84:87], a[148:151], a[40:43]
    s_mov_b32 m0, s49
    v_exp_f32 v51, v51
    v_mfma_f32_16x16x32_bf16 a[44:47], v[92:95], a[148:151], a[44:47]
    ds_read_b128 a[140:143], v4 offset:24576
    v_cvt_pk_bf16_f32 v99, v50, v51
    v_mfma_f32_16x16x32_bf16 a[44:47], v[88:91], a[144:147], a[44:47]
    s_add_u32 s29, s29, 0x2000
    v_exp_f32 v52, v52
    v_mfma_f32_16x16x32_bf16 a[48:51], v[64:67], a[152:155], a[48:51]
    buffer_load_dwordx4 v13, s[16:19], s29 offen offset:0 nt lds
    v_mfma_f32_16x16x32_bf16 a[48:51], v[68:71], a[156:159], a[48:51]
    v_exp_f32 v53, v53
    v_mfma_f32_16x16x32_bf16 a[52:55], v[76:79], a[156:159], a[52:55]
    v_cvt_pk_bf16_f32 v106, v52, v53
    v_mfma_f32_16x16x32_bf16 a[52:55], v[72:75], a[152:155], a[52:55]
    v_exp_f32 v54, v54
    v_mfma_f32_16x16x32_bf16 a[56:59], v[80:83], a[152:155], a[56:59]
    buffer_load_dwordx4 v14, s[16:19], s29 offen offset:1024 nt lds
    v_mfma_f32_16x16x32_bf16 a[56:59], v[84:87], a[156:159], a[56:59]
    v_exp_f32 v55, v55
    v_mfma_f32_16x16x32_bf16 a[60:63], v[92:95], a[156:159], a[60:63]
    v_cvt_pk_bf16_f32 v107, v54, v55
    v_mfma_f32_16x16x32_bf16 a[60:63], v[88:91], a[152:155], a[60:63]
    s_waitcnt lgkmcnt(0)
    v_mfma_f32_16x16x32_bf16 v[32:35], a[128:131], v[160:163], v[128:131]
    ds_read_b64_tr_b16 a[144:145], v9 offset:0
    ds_read_b64_tr_b16 a[146:147], v9 offset:4096
    v_mfma_f32_16x16x32_bf16 v[32:35], a[132:135], v[164:167], v[32:35]
    v_exp_f32 v56, v56
    v_mfma_f32_16x16x32_bf16 v[32:35], a[136:139], v[168:171], v[32:35]
    ds_read_b64_tr_b16 a[148:149], v9 offset:8192
    ds_read_b64_tr_b16 a[150:151], v9 offset:12288
    v_mfma_f32_16x16x32_bf16 v[32:35], a[140:143], v[172:175], v[32:35]
    v_exp_f32 v57, v57
    v_mfma_f32_16x16x32_bf16 v[36:39], a[140:143], v[188:191], v[132:135]
    ds_read_b64_tr_b16 a[152:153], v10 offset:0
    ds_read_b64_tr_b16 a[154:155], v10 offset:4096
    v_mfma_f32_16x16x32_bf16 v[36:39], a[136:139], v[184:187], v[36:39]
    v_exp_f32 v58, v58
    v_mfma_f32_16x16x32_bf16 v[36:39], a[132:135], v[180:183], v[36:39]
    ds_read_b64_tr_b16 a[156:157], v10 offset:8192
    ds_read_b64_tr_b16 a[158:159], v10 offset:12288
    v_mfma_f32_16x16x32_bf16 v[36:39], a[128:131], v[176:179], v[36:39]
    v_exp_f32 v59, v59
    v_mfma_f32_16x16x32_bf16 v[40:43], a[128:131], v[192:195], v[136:139]
    v_cvt_pk_bf16_f32 v114, v56, v57
    v_cvt_pk_bf16_f32 v115, v58, v59
    v_mfma_f32_16x16x32_bf16 v[40:43], a[132:135], v[196:199], v[40:43]
    v_exp_f32 v60, v60
    v_mfma_f32_16x16x32_bf16 v[40:43], a[136:139], v[200:203], v[40:43]
    v_mfma_f32_16x16x32_bf16 v[40:43], a[140:143], v[204:207], v[40:43]
    v_exp_f32 v61, v61
    v_mfma_f32_16x16x32_bf16 v[44:47], a[140:143], v[220:223], v[140:143]
    v_cvt_pk_bf16_f32 v122, v60, v61
    v_mfma_f32_16x16x32_bf16 v[44:47], a[136:139], v[216:219], v[44:47]
    v_exp_f32 v62, v62
    v_mfma_f32_16x16x32_bf16 v[44:47], a[132:135], v[212:215], v[44:47]
    v_mfma_f32_16x16x32_bf16 v[44:47], a[128:131], v[208:211], v[44:47]
    v_exp_f32 v63, v63
    v_mfma_f32_16x16x32_bf16 v[144:147], v[80:83], a[168:171], v[144:147]
    v_cvt_pk_bf16_f32 v123, v62, v63
    v_mfma_f32_16x16x32_bf16 v[144:147], v[84:87], a[168:171], v[144:147]
    s_waitcnt lgkmcnt(0)
    v_exp_f32 v32, v32
    v_mfma_f32_16x16x32_bf16 a[64:67], v[64:67], a[144:147], a[64:67]
    ds_read_b128 a[128:131], v1 offset:28672
    v_mfma_f32_16x16x32_bf16 a[64:67], v[68:71], a[148:151], a[64:67]
    v_exp_f32 v33, v33
    v_mfma_f32_16x16x32_bf16 a[68:71], v[76:79], a[148:151], a[68:71]
    ds_read_b128 a[132:135], v2 offset:28672
    v_cvt_pk_bf16_f32 v100, v32, v33
    v_mfma_f32_16x16x32_bf16 a[68:71], v[72:75], a[144:147], a[68:71]
    v_exp_f32 v34, v34
    v_mfma_f32_16x16x32_bf16 a[72:75], v[80:83], a[144:147], a[72:75]
    ds_read_b128 a[136:139], v3 offset:28672
    v_mfma_f32_16x16x32_bf16 a[72:75], v[84:87], a[148:151], a[72:75]
    v_exp_f32 v35, v35
    v_mfma_f32_16x16x32_bf16 a[76:79], v[92:95], a[148:151], a[76:79]
    ds_read_b128 a[140:143], v4 offset:28672
    v_cvt_pk_bf16_f32 v101, v34, v35
    v_mfma_f32_16x16x32_bf16 a[76:79], v[88:91], a[144:147], a[76:79]
    v_exp_f32 v36, v36
    v_mfma_f32_16x16x32_bf16 a[80:83], v[64:67], a[152:155], a[80:83]
    buffer_load_dwordx4 v15, s[16:19], s29 offen offset:2048 nt lds
    v_mfma_f32_16x16x32_bf16 a[80:83], v[68:71], a[156:159], a[80:83]
    v_exp_f32 v37, v37
    v_mfma_f32_16x16x32_bf16 a[84:87], v[76:79], a[156:159], a[84:87]
    v_cvt_pk_bf16_f32 v108, v36, v37
    v_mfma_f32_16x16x32_bf16 a[84:87], v[72:75], a[152:155], a[84:87]
    v_exp_f32 v38, v38
    v_mfma_f32_16x16x32_bf16 a[88:91], v[80:83], a[152:155], a[88:91]
    buffer_load_dwordx4 v16, s[16:19], s29 offen offset:3072 nt lds
    v_mfma_f32_16x16x32_bf16 a[88:91], v[84:87], a[156:159], a[88:91]
    v_exp_f32 v39, v39
    v_mfma_f32_16x16x32_bf16 a[92:95], v[92:95], a[156:159], a[92:95]
    v_cvt_pk_bf16_f32 v109, v38, v39
    v_mfma_f32_16x16x32_bf16 a[92:95], v[88:91], a[152:155], a[92:95]
    s_waitcnt lgkmcnt(0)
    v_mfma_f32_16x16x32_bf16 v[48:51], a[128:131], v[160:163], v[128:131]
    ds_read_b64_tr_b16 a[144:145], v11 offset:0
    ds_read_b64_tr_b16 a[146:147], v11 offset:4096
    v_mfma_f32_16x16x32_bf16 v[48:51], a[132:135], v[164:167], v[48:51]
    v_exp_f32 v40, v40
    v_mfma_f32_16x16x32_bf16 v[48:51], a[136:139], v[168:171], v[48:51]
    ds_read_b64_tr_b16 a[148:149], v11 offset:8192
    ds_read_b64_tr_b16 a[150:151], v11 offset:12288
    v_mfma_f32_16x16x32_bf16 v[48:51], a[140:143], v[172:175], v[48:51]
    v_exp_f32 v41, v41
    v_mfma_f32_16x16x32_bf16 v[52:55], a[140:143], v[188:191], v[132:135]
    ds_read_b64_tr_b16 a[152:153], v12 offset:0
    ds_read_b64_tr_b16 a[154:155], v12 offset:4096
    v_mfma_f32_16x16x32_bf16 v[52:55], a[136:139], v[184:187], v[52:55]
    v_exp_f32 v42, v42
    v_mfma_f32_16x16x32_bf16 v[52:55], a[132:135], v[180:183], v[52:55]
    ds_read_b64_tr_b16 a[156:157], v12 offset:8192
    ds_read_b64_tr_b16 a[158:159], v12 offset:12288
    v_mfma_f32_16x16x32_bf16 v[52:55], a[128:131], v[176:179], v[52:55]
    v_exp_f32 v43, v43
    v_mfma_f32_16x16x32_bf16 v[56:59], a[128:131], v[192:195], v[136:139]
    v_cvt_pk_bf16_f32 v116, v40, v41
    v_cvt_pk_bf16_f32 v117, v42, v43
    v_mfma_f32_16x16x32_bf16 v[56:59], a[132:135], v[196:199], v[56:59]
    v_exp_f32 v44, v44
    v_mfma_f32_16x16x32_bf16 v[56:59], a[136:139], v[200:203], v[56:59]
    v_mfma_f32_16x16x32_bf16 v[56:59], a[140:143], v[204:207], v[56:59]
    v_exp_f32 v45, v45
    v_mfma_f32_16x16x32_bf16 v[60:63], a[140:143], v[220:223], v[140:143]
    v_cvt_pk_bf16_f32 v124, v44, v45
    v_mfma_f32_16x16x32_bf16 v[60:63], a[136:139], v[216:219], v[60:63]
    v_exp_f32 v46, v46
    v_mfma_f32_16x16x32_bf16 v[60:63], a[132:135], v[212:215], v[60:63]
    v_mfma_f32_16x16x32_bf16 v[60:63], a[128:131], v[208:211], v[60:63]
    v_exp_f32 v47, v47
    v_mfma_f32_16x16x32_bf16 v[144:147], v[88:91], a[172:175], v[144:147]
    v_cvt_pk_bf16_f32 v125, v46, v47
    v_mfma_f32_16x16x32_bf16 v[144:147], v[92:95], a[172:175], v[144:147]
    s_waitcnt vmcnt(16) lgkmcnt(0)
    v_exp_f32 v48, v48
    v_mfma_f32_16x16x32_bf16 a[96:99], v[64:67], a[144:147], a[96:99]
    s_barrier
    ds_read_b128 a[128:131], v1 offset:32768
    v_mfma_f32_16x16x32_bf16 a[96:99], v[68:71], a[148:151], a[96:99]
    v_exp_f32 v49, v49
    v_mfma_f32_16x16x32_bf16 a[100:103], v[76:79], a[148:151], a[100:103]
    ds_read_b128 a[132:135], v2 offset:32768
    v_cvt_pk_bf16_f32 v102, v48, v49
    v_mfma_f32_16x16x32_bf16 a[100:103], v[72:75], a[144:147], a[100:103]
    v_exp_f32 v50, v50
    v_mfma_f32_16x16x32_bf16 a[104:107], v[80:83], a[144:147], a[104:107]
    ds_read_b128 a[136:139], v3 offset:32768
    v_mfma_f32_16x16x32_bf16 a[104:107], v[84:87], a[148:151], a[104:107]
    v_exp_f32 v51, v51
    v_mfma_f32_16x16x32_bf16 a[108:111], v[92:95], a[148:151], a[108:111]
    ds_read_b128 a[140:143], v4 offset:32768
    v_cvt_pk_bf16_f32 v103, v50, v51
    v_mfma_f32_16x16x32_bf16 a[108:111], v[88:91], a[144:147], a[108:111]
    v_exp_f32 v52, v52
    v_mfma_f32_16x16x32_bf16 a[112:115], v[64:67], a[152:155], a[112:115]
    v_mfma_f32_16x16x32_bf16 a[112:115], v[68:71], a[156:159], a[112:115]
    v_exp_f32 v53, v53
    v_mfma_f32_16x16x32_bf16 a[116:119], v[76:79], a[156:159], a[116:119]
    v_cvt_pk_bf16_f32 v110, v52, v53
    v_mfma_f32_16x16x32_bf16 a[116:119], v[72:75], a[152:155], a[116:119]
    v_exp_f32 v54, v54
    v_mfma_f32_16x16x32_bf16 a[120:123], v[80:83], a[152:155], a[120:123]
    v_mfma_f32_16x16x32_bf16 a[120:123], v[84:87], a[156:159], a[120:123]
    v_exp_f32 v55, v55
    v_mfma_f32_16x16x32_bf16 a[124:127], v[92:95], a[156:159], a[124:127]
    v_cvt_pk_bf16_f32 v111, v54, v55
    v_mfma_f32_16x16x32_bf16 a[124:127], v[88:91], a[152:155], a[124:127]
    s_waitcnt lgkmcnt(0)
    v_mfma_f32_16x16x32_bf16 v[32:35], a[128:131], v[160:163], v[128:131]
    ds_read_b64_tr_b16 a[144:145], v5 offset:16384
    ds_read_b64_tr_b16 a[146:147], v5 offset:20480
    v_mfma_f32_16x16x32_bf16 v[32:35], a[132:135], v[164:167], v[32:35]
    v_exp_f32 v56, v56
    v_mfma_f32_16x16x32_bf16 v[32:35], a[136:139], v[168:171], v[32:35]
    ds_read_b64_tr_b16 a[148:149], v5 offset:24576
    ds_read_b64_tr_b16 a[150:151], v5 offset:28672
    v_mfma_f32_16x16x32_bf16 v[32:35], a[140:143], v[172:175], v[32:35]
    v_exp_f32 v57, v57
    v_mfma_f32_16x16x32_bf16 v[36:39], a[140:143], v[188:191], v[132:135]
    ds_read_b64_tr_b16 a[152:153], v6 offset:16384
    ds_read_b64_tr_b16 a[154:155], v6 offset:20480
    v_mfma_f32_16x16x32_bf16 v[36:39], a[136:139], v[184:187], v[36:39]
    v_exp_f32 v58, v58
    v_mfma_f32_16x16x32_bf16 v[36:39], a[132:135], v[180:183], v[36:39]
    ds_read_b64_tr_b16 a[156:157], v6 offset:24576
    ds_read_b64_tr_b16 a[158:159], v6 offset:28672
    v_mfma_f32_16x16x32_bf16 v[36:39], a[128:131], v[176:179], v[36:39]
    v_exp_f32 v59, v59
    v_mfma_f32_16x16x32_bf16 v[40:43], a[128:131], v[192:195], v[136:139]
    v_cvt_pk_bf16_f32 v118, v56, v57
    v_cvt_pk_bf16_f32 v119, v58, v59
    v_mfma_f32_16x16x32_bf16 v[40:43], a[132:135], v[196:199], v[40:43]
    v_exp_f32 v60, v60
    v_mfma_f32_16x16x32_bf16 v[40:43], a[136:139], v[200:203], v[40:43]
    v_mfma_f32_16x16x32_bf16 v[40:43], a[140:143], v[204:207], v[40:43]
    v_exp_f32 v61, v61
    v_mfma_f32_16x16x32_bf16 v[44:47], a[140:143], v[220:223], v[140:143]
    v_cvt_pk_bf16_f32 v126, v60, v61
    v_mfma_f32_16x16x32_bf16 v[44:47], a[136:139], v[216:219], v[44:47]
    v_exp_f32 v62, v62
    v_mfma_f32_16x16x32_bf16 v[44:47], a[132:135], v[212:215], v[44:47]
    v_mfma_f32_16x16x32_bf16 v[44:47], a[128:131], v[208:211], v[44:47]
    v_exp_f32 v63, v63
    v_mfma_f32_16x16x32_bf16 v[144:147], v[96:99], a[160:163], v[144:147]
    v_cvt_pk_bf16_f32 v127, v62, v63
    v_mfma_f32_16x16x32_bf16 v[144:147], v[100:103], a[160:163], v[144:147]
    s_waitcnt lgkmcnt(0)
    v_exp_f32 v32, v32
    v_mfma_f32_16x16x32_bf16 a[0:3], v[96:99], a[144:147], a[0:3]
    ds_read_b128 a[128:131], v1 offset:36864
    v_mfma_f32_16x16x32_bf16 a[0:3], v[100:103], a[148:151], a[0:3]
    v_exp_f32 v33, v33
    v_mfma_f32_16x16x32_bf16 a[4:7], v[108:111], a[148:151], a[4:7]
    ds_read_b128 a[132:135], v2 offset:36864
    v_cvt_pk_bf16_f32 v64, v32, v33
    v_mfma_f32_16x16x32_bf16 a[4:7], v[104:107], a[144:147], a[4:7]
    v_exp_f32 v34, v34
    v_mfma_f32_16x16x32_bf16 a[8:11], v[112:115], a[144:147], a[8:11]
    ds_read_b128 a[136:139], v3 offset:36864
    v_mfma_f32_16x16x32_bf16 a[8:11], v[116:119], a[148:151], a[8:11]
    v_exp_f32 v35, v35
    v_mfma_f32_16x16x32_bf16 a[12:15], v[124:127], a[148:151], a[12:15]
    ds_read_b128 a[140:143], v4 offset:36864
    v_cvt_pk_bf16_f32 v65, v34, v35
    v_mfma_f32_16x16x32_bf16 a[12:15], v[120:123], a[144:147], a[12:15]
    v_exp_f32 v36, v36
    v_mfma_f32_16x16x32_bf16 a[16:19], v[96:99], a[152:155], a[16:19]
    v_mfma_f32_16x16x32_bf16 a[16:19], v[100:103], a[156:159], a[16:19]
    v_exp_f32 v37, v37
    v_mfma_f32_16x16x32_bf16 a[20:23], v[108:111], a[156:159], a[20:23]
    v_cvt_pk_bf16_f32 v72, v36, v37
    v_mfma_f32_16x16x32_bf16 a[20:23], v[104:107], a[152:155], a[20:23]
    v_exp_f32 v38, v38
    v_mfma_f32_16x16x32_bf16 a[24:27], v[112:115], a[152:155], a[24:27]
    v_mfma_f32_16x16x32_bf16 a[24:27], v[116:119], a[156:159], a[24:27]
    v_exp_f32 v39, v39
    v_mfma_f32_16x16x32_bf16 a[28:31], v[124:127], a[156:159], a[28:31]
    v_cvt_pk_bf16_f32 v73, v38, v39
    v_mfma_f32_16x16x32_bf16 a[28:31], v[120:123], a[152:155], a[28:31]
    s_waitcnt lgkmcnt(0)
    v_mfma_f32_16x16x32_bf16 v[48:51], a[128:131], v[160:163], v[128:131]
    ds_read_b64_tr_b16 a[144:145], v7 offset:16384
    ds_read_b64_tr_b16 a[146:147], v7 offset:20480
    v_mfma_f32_16x16x32_bf16 v[48:51], a[132:135], v[164:167], v[48:51]
    v_exp_f32 v40, v40
    v_mfma_f32_16x16x32_bf16 v[48:51], a[136:139], v[168:171], v[48:51]
    ds_read_b64_tr_b16 a[148:149], v7 offset:24576
    ds_read_b64_tr_b16 a[150:151], v7 offset:28672
    v_mfma_f32_16x16x32_bf16 v[48:51], a[140:143], v[172:175], v[48:51]
    v_exp_f32 v41, v41
    v_mfma_f32_16x16x32_bf16 v[52:55], a[140:143], v[188:191], v[132:135]
    ds_read_b64_tr_b16 a[152:153], v8 offset:16384
    ds_read_b64_tr_b16 a[154:155], v8 offset:20480
    v_mfma_f32_16x16x32_bf16 v[52:55], a[136:139], v[184:187], v[52:55]
    v_exp_f32 v42, v42
    v_mfma_f32_16x16x32_bf16 v[52:55], a[132:135], v[180:183], v[52:55]
    ds_read_b64_tr_b16 a[156:157], v8 offset:24576
    ds_read_b64_tr_b16 a[158:159], v8 offset:28672
    v_mfma_f32_16x16x32_bf16 v[52:55], a[128:131], v[176:179], v[52:55]
    v_exp_f32 v43, v43
    v_mfma_f32_16x16x32_bf16 v[56:59], a[128:131], v[192:195], v[136:139]
    v_cvt_pk_bf16_f32 v80, v40, v41
    v_cvt_pk_bf16_f32 v81, v42, v43
    v_mfma_f32_16x16x32_bf16 v[56:59], a[132:135], v[196:199], v[56:59]
    v_exp_f32 v44, v44
    v_mfma_f32_16x16x32_bf16 v[56:59], a[136:139], v[200:203], v[56:59]
    v_mfma_f32_16x16x32_bf16 v[56:59], a[140:143], v[204:207], v[56:59]
    v_exp_f32 v45, v45
    v_mfma_f32_16x16x32_bf16 v[60:63], a[140:143], v[220:223], v[140:143]
    v_cvt_pk_bf16_f32 v88, v44, v45
    v_mfma_f32_16x16x32_bf16 v[60:63], a[136:139], v[216:219], v[60:63]
    v_exp_f32 v46, v46
    v_mfma_f32_16x16x32_bf16 v[60:63], a[132:135], v[212:215], v[60:63]
    v_mfma_f32_16x16x32_bf16 v[60:63], a[128:131], v[208:211], v[60:63]
    v_exp_f32 v47, v47
    v_mfma_f32_16x16x32_bf16 v[144:147], v[104:107], a[164:167], v[144:147]
    v_cvt_pk_bf16_f32 v89, v46, v47
    v_mfma_f32_16x16x32_bf16 v[144:147], v[108:111], a[164:167], v[144:147]
    s_waitcnt lgkmcnt(0)
    v_exp_f32 v48, v48
    v_mfma_f32_16x16x32_bf16 a[32:35], v[96:99], a[144:147], a[32:35]
    ds_read_b128 a[128:131], v1 offset:40960
    v_mfma_f32_16x16x32_bf16 a[32:35], v[100:103], a[148:151], a[32:35]
    v_exp_f32 v49, v49
    v_mfma_f32_16x16x32_bf16 a[36:39], v[108:111], a[148:151], a[36:39]
    ds_read_b128 a[132:135], v2 offset:40960
    v_cvt_pk_bf16_f32 v66, v48, v49
    v_mfma_f32_16x16x32_bf16 a[36:39], v[104:107], a[144:147], a[36:39]
    v_exp_f32 v50, v50
    v_mfma_f32_16x16x32_bf16 a[40:43], v[112:115], a[144:147], a[40:43]
    ds_read_b128 a[136:139], v3 offset:40960
    v_mfma_f32_16x16x32_bf16 a[40:43], v[116:119], a[148:151], a[40:43]
    v_exp_f32 v51, v51
    v_mfma_f32_16x16x32_bf16 a[44:47], v[124:127], a[148:151], a[44:47]
    ds_read_b128 a[140:143], v4 offset:40960
    v_cvt_pk_bf16_f32 v67, v50, v51
    v_mfma_f32_16x16x32_bf16 a[44:47], v[120:123], a[144:147], a[44:47]
    v_exp_f32 v52, v52
    v_mfma_f32_16x16x32_bf16 a[48:51], v[96:99], a[152:155], a[48:51]
    v_mfma_f32_16x16x32_bf16 a[48:51], v[100:103], a[156:159], a[48:51]
    v_exp_f32 v53, v53
    v_mfma_f32_16x16x32_bf16 a[52:55], v[108:111], a[156:159], a[52:55]
    v_cvt_pk_bf16_f32 v74, v52, v53
    v_mfma_f32_16x16x32_bf16 a[52:55], v[104:107], a[152:155], a[52:55]
    v_exp_f32 v54, v54
    v_mfma_f32_16x16x32_bf16 a[56:59], v[112:115], a[152:155], a[56:59]
    v_mfma_f32_16x16x32_bf16 a[56:59], v[116:119], a[156:159], a[56:59]
    v_exp_f32 v55, v55
    v_mfma_f32_16x16x32_bf16 a[60:63], v[124:127], a[156:159], a[60:63]
    v_cvt_pk_bf16_f32 v75, v54, v55
    v_mfma_f32_16x16x32_bf16 a[60:63], v[120:123], a[152:155], a[60:63]
    s_waitcnt lgkmcnt(0)
    v_mfma_f32_16x16x32_bf16 v[32:35], a[128:131], v[160:163], v[128:131]
    ds_read_b64_tr_b16 a[144:145], v9 offset:16384
    ds_read_b64_tr_b16 a[146:147], v9 offset:20480
    v_mfma_f32_16x16x32_bf16 v[32:35], a[132:135], v[164:167], v[32:35]
    v_exp_f32 v56, v56
    v_mfma_f32_16x16x32_bf16 v[32:35], a[136:139], v[168:171], v[32:35]
    ds_read_b64_tr_b16 a[148:149], v9 offset:24576
    ds_read_b64_tr_b16 a[150:151], v9 offset:28672
    v_mfma_f32_16x16x32_bf16 v[32:35], a[140:143], v[172:175], v[32:35]
    v_exp_f32 v57, v57
    v_mfma_f32_16x16x32_bf16 v[36:39], a[140:143], v[188:191], v[132:135]
    ds_read_b64_tr_b16 a[152:153], v10 offset:16384
    ds_read_b64_tr_b16 a[154:155], v10 offset:20480
    v_mfma_f32_16x16x32_bf16 v[36:39], a[136:139], v[184:187], v[36:39]
    v_exp_f32 v58, v58
    v_mfma_f32_16x16x32_bf16 v[36:39], a[132:135], v[180:183], v[36:39]
    ds_read_b64_tr_b16 a[156:157], v10 offset:24576
    ds_read_b64_tr_b16 a[158:159], v10 offset:28672
    v_mfma_f32_16x16x32_bf16 v[36:39], a[128:131], v[176:179], v[36:39]
    v_exp_f32 v59, v59
    v_mfma_f32_16x16x32_bf16 v[40:43], a[128:131], v[192:195], v[136:139]
    v_cvt_pk_bf16_f32 v82, v56, v57
    v_cvt_pk_bf16_f32 v83, v58, v59
    v_mfma_f32_16x16x32_bf16 v[40:43], a[132:135], v[196:199], v[40:43]
    v_exp_f32 v60, v60
    v_mfma_f32_16x16x32_bf16 v[40:43], a[136:139], v[200:203], v[40:43]
    v_mfma_f32_16x16x32_bf16 v[40:43], a[140:143], v[204:207], v[40:43]
    v_exp_f32 v61, v61
    v_mfma_f32_16x16x32_bf16 v[44:47], a[140:143], v[220:223], v[140:143]
    v_cvt_pk_bf16_f32 v90, v60, v61
    v_mfma_f32_16x16x32_bf16 v[44:47], a[136:139], v[216:219], v[44:47]
    v_exp_f32 v62, v62
    v_mfma_f32_16x16x32_bf16 v[44:47], a[132:135], v[212:215], v[44:47]
    v_mfma_f32_16x16x32_bf16 v[44:47], a[128:131], v[208:211], v[44:47]
    v_exp_f32 v63, v63
    v_mfma_f32_16x16x32_bf16 v[144:147], v[112:115], a[168:171], v[144:147]
    v_cvt_pk_bf16_f32 v91, v62, v63
    v_mfma_f32_16x16x32_bf16 v[144:147], v[116:119], a[168:171], v[144:147]
    s_waitcnt lgkmcnt(0)
    v_exp_f32 v32, v32
    v_mfma_f32_16x16x32_bf16 a[64:67], v[96:99], a[144:147], a[64:67]
    ds_read_b128 a[128:131], v1 offset:45056
    v_mfma_f32_16x16x32_bf16 a[64:67], v[100:103], a[148:151], a[64:67]
    v_exp_f32 v33, v33
    v_mfma_f32_16x16x32_bf16 a[68:71], v[108:111], a[148:151], a[68:71]
    ds_read_b128 a[132:135], v2 offset:45056
    v_cvt_pk_bf16_f32 v68, v32, v33
    v_mfma_f32_16x16x32_bf16 a[68:71], v[104:107], a[144:147], a[68:71]
    v_exp_f32 v34, v34
    v_mfma_f32_16x16x32_bf16 a[72:75], v[112:115], a[144:147], a[72:75]
    ds_read_b128 a[136:139], v3 offset:45056
    v_mfma_f32_16x16x32_bf16 a[72:75], v[116:119], a[148:151], a[72:75]
    v_exp_f32 v35, v35
    v_mfma_f32_16x16x32_bf16 a[76:79], v[124:127], a[148:151], a[76:79]
    ds_read_b128 a[140:143], v4 offset:45056
    v_cvt_pk_bf16_f32 v69, v34, v35
    v_mfma_f32_16x16x32_bf16 a[76:79], v[120:123], a[144:147], a[76:79]
    v_exp_f32 v36, v36
    v_mfma_f32_16x16x32_bf16 a[80:83], v[96:99], a[152:155], a[80:83]
    v_mfma_f32_16x16x32_bf16 a[80:83], v[100:103], a[156:159], a[80:83]
    v_exp_f32 v37, v37
    v_mfma_f32_16x16x32_bf16 a[84:87], v[108:111], a[156:159], a[84:87]
    v_cvt_pk_bf16_f32 v76, v36, v37
    v_mfma_f32_16x16x32_bf16 a[84:87], v[104:107], a[152:155], a[84:87]
    v_exp_f32 v38, v38
    v_mfma_f32_16x16x32_bf16 a[88:91], v[112:115], a[152:155], a[88:91]
    v_mfma_f32_16x16x32_bf16 a[88:91], v[116:119], a[156:159], a[88:91]
    v_exp_f32 v39, v39
    v_mfma_f32_16x16x32_bf16 a[92:95], v[124:127], a[156:159], a[92:95]
    v_cvt_pk_bf16_f32 v77, v38, v39
    v_mfma_f32_16x16x32_bf16 a[92:95], v[120:123], a[152:155], a[92:95]
    s_waitcnt lgkmcnt(0)
    v_mfma_f32_16x16x32_bf16 v[48:51], a[128:131], v[160:163], v[128:131]
    ds_read_b64_tr_b16 a[144:145], v11 offset:16384
    ds_read_b64_tr_b16 a[146:147], v11 offset:20480
    v_mfma_f32_16x16x32_bf16 v[48:51], a[132:135], v[164:167], v[48:51]
    v_exp_f32 v40, v40
    v_mfma_f32_16x16x32_bf16 v[48:51], a[136:139], v[168:171], v[48:51]
    ds_read_b64_tr_b16 a[148:149], v11 offset:24576
    ds_read_b64_tr_b16 a[150:151], v11 offset:28672
    v_mfma_f32_16x16x32_bf16 v[48:51], a[140:143], v[172:175], v[48:51]
    v_exp_f32 v41, v41
    v_mfma_f32_16x16x32_bf16 v[52:55], a[140:143], v[188:191], v[132:135]
    ds_read_b64_tr_b16 a[152:153], v12 offset:16384
    ds_read_b64_tr_b16 a[154:155], v12 offset:20480
    v_mfma_f32_16x16x32_bf16 v[52:55], a[136:139], v[184:187], v[52:55]
    v_exp_f32 v42, v42
    v_mfma_f32_16x16x32_bf16 v[52:55], a[132:135], v[180:183], v[52:55]
    ds_read_b64_tr_b16 a[156:157], v12 offset:24576
    ds_read_b64_tr_b16 a[158:159], v12 offset:28672
    v_mfma_f32_16x16x32_bf16 v[52:55], a[128:131], v[176:179], v[52:55]
    v_exp_f32 v43, v43
    v_mfma_f32_16x16x32_bf16 v[56:59], a[128:131], v[192:195], v[136:139]
    v_cvt_pk_bf16_f32 v84, v40, v41
    v_cvt_pk_bf16_f32 v85, v42, v43
    v_mfma_f32_16x16x32_bf16 v[56:59], a[132:135], v[196:199], v[56:59]
    v_exp_f32 v44, v44
    v_mfma_f32_16x16x32_bf16 v[56:59], a[136:139], v[200:203], v[56:59]
    v_mfma_f32_16x16x32_bf16 v[56:59], a[140:143], v[204:207], v[56:59]
    v_exp_f32 v45, v45
    v_mfma_f32_16x16x32_bf16 v[60:63], a[140:143], v[220:223], v[140:143]
    v_cvt_pk_bf16_f32 v92, v44, v45
    v_mfma_f32_16x16x32_bf16 v[60:63], a[136:139], v[216:219], v[60:63]
    v_exp_f32 v46, v46
    v_mfma_f32_16x16x32_bf16 v[60:63], a[132:135], v[212:215], v[60:63]
    v_mfma_f32_16x16x32_bf16 v[60:63], a[128:131], v[208:211], v[60:63]
    v_exp_f32 v47, v47
    v_mfma_f32_16x16x32_bf16 v[144:147], v[120:123], a[172:175], v[144:147]
    v_cvt_pk_bf16_f32 v93, v46, v47
    v_mfma_f32_16x16x32_bf16 v[144:147], v[124:127], a[172:175], v[144:147]
    s_waitcnt vmcnt(8) lgkmcnt(0)
    v_exp_f32 v48, v48
    v_mfma_f32_16x16x32_bf16 a[96:99], v[96:99], a[144:147], a[96:99]
    s_barrier
    ds_read_b128 a[128:131], v1 offset:49152
    v_mfma_f32_16x16x32_bf16 a[96:99], v[100:103], a[148:151], a[96:99]
    v_exp_f32 v49, v49
    v_mfma_f32_16x16x32_bf16 a[100:103], v[108:111], a[148:151], a[100:103]
    ds_read_b128 a[132:135], v2 offset:49152
    v_cvt_pk_bf16_f32 v70, v48, v49
    v_mfma_f32_16x16x32_bf16 a[100:103], v[104:107], a[144:147], a[100:103]
    v_exp_f32 v50, v50
    v_mfma_f32_16x16x32_bf16 a[104:107], v[112:115], a[144:147], a[104:107]
    ds_read_b128 a[136:139], v3 offset:49152
    v_mfma_f32_16x16x32_bf16 a[104:107], v[116:119], a[148:151], a[104:107]
    v_exp_f32 v51, v51
    v_mfma_f32_16x16x32_bf16 a[108:111], v[124:127], a[148:151], a[108:111]
    ds_read_b128 a[140:143], v4 offset:49152
    v_cvt_pk_bf16_f32 v71, v50, v51
    v_mfma_f32_16x16x32_bf16 a[108:111], v[120:123], a[144:147], a[108:111]
    v_exp_f32 v52, v52
    v_mfma_f32_16x16x32_bf16 a[112:115], v[96:99], a[152:155], a[112:115]
    v_mfma_f32_16x16x32_bf16 a[112:115], v[100:103], a[156:159], a[112:115]
    v_exp_f32 v53, v53
    v_mfma_f32_16x16x32_bf16 a[116:119], v[108:111], a[156:159], a[116:119]
    v_cvt_pk_bf16_f32 v78, v52, v53
    v_mfma_f32_16x16x32_bf16 a[116:119], v[104:107], a[152:155], a[116:119]
    v_exp_f32 v54, v54
    v_mfma_f32_16x16x32_bf16 a[120:123], v[112:115], a[152:155], a[120:123]
    v_mfma_f32_16x16x32_bf16 a[120:123], v[116:119], a[156:159], a[120:123]
    v_exp_f32 v55, v55
    v_mfma_f32_16x16x32_bf16 a[124:127], v[124:127], a[156:159], a[124:127]
    v_cvt_pk_bf16_f32 v79, v54, v55
    v_mfma_f32_16x16x32_bf16 a[124:127], v[120:123], a[152:155], a[124:127]
    s_waitcnt lgkmcnt(0)
    v_mfma_f32_16x16x32_bf16 v[32:35], a[128:131], v[160:163], v[128:131]
    ds_read_b64_tr_b16 a[144:145], v5 offset:32768
    ds_read_b64_tr_b16 a[146:147], v5 offset:36864
    v_mfma_f32_16x16x32_bf16 v[32:35], a[132:135], v[164:167], v[32:35]
    v_exp_f32 v56, v56
    v_mfma_f32_16x16x32_bf16 v[32:35], a[136:139], v[168:171], v[32:35]
    ds_read_b64_tr_b16 a[148:149], v5 offset:40960
    ds_read_b64_tr_b16 a[150:151], v5 offset:45056
    v_mfma_f32_16x16x32_bf16 v[32:35], a[140:143], v[172:175], v[32:35]
    v_exp_f32 v57, v57
    v_mfma_f32_16x16x32_bf16 v[36:39], a[140:143], v[188:191], v[132:135]
    ds_read_b64_tr_b16 a[152:153], v6 offset:32768
    ds_read_b64_tr_b16 a[154:155], v6 offset:36864
    v_mfma_f32_16x16x32_bf16 v[36:39], a[136:139], v[184:187], v[36:39]
    v_exp_f32 v58, v58
    v_mfma_f32_16x16x32_bf16 v[36:39], a[132:135], v[180:183], v[36:39]
    ds_read_b64_tr_b16 a[156:157], v6 offset:40960
    ds_read_b64_tr_b16 a[158:159], v6 offset:45056
    v_mfma_f32_16x16x32_bf16 v[36:39], a[128:131], v[176:179], v[36:39]
    v_exp_f32 v59, v59
    v_mfma_f32_16x16x32_bf16 v[40:43], a[128:131], v[192:195], v[136:139]
    v_cvt_pk_bf16_f32 v86, v56, v57
    v_cvt_pk_bf16_f32 v87, v58, v59
    v_mfma_f32_16x16x32_bf16 v[40:43], a[132:135], v[196:199], v[40:43]
    v_exp_f32 v60, v60
    v_mfma_f32_16x16x32_bf16 v[40:43], a[136:139], v[200:203], v[40:43]
    v_mfma_f32_16x16x32_bf16 v[40:43], a[140:143], v[204:207], v[40:43]
    v_exp_f32 v61, v61
    v_mfma_f32_16x16x32_bf16 v[44:47], a[140:143], v[220:223], v[140:143]
    v_cvt_pk_bf16_f32 v94, v60, v61
    v_mfma_f32_16x16x32_bf16 v[44:47], a[136:139], v[216:219], v[44:47]
    v_exp_f32 v62, v62
    v_mfma_f32_16x16x32_bf16 v[44:47], a[132:135], v[212:215], v[44:47]
    v_mfma_f32_16x16x32_bf16 v[44:47], a[128:131], v[208:211], v[44:47]
    v_exp_f32 v63, v63
    v_mfma_f32_16x16x32_bf16 v[144:147], v[64:67], a[160:163], v[144:147]
    v_cvt_pk_bf16_f32 v95, v62, v63
    v_mfma_f32_16x16x32_bf16 v[144:147], v[68:71], a[160:163], v[144:147]
    s_waitcnt lgkmcnt(0)
    v_exp_f32 v32, v32
    v_mfma_f32_16x16x32_bf16 a[0:3], v[64:67], a[144:147], a[0:3]
    ds_read_b128 a[128:131], v1 offset:53248
    v_mfma_f32_16x16x32_bf16 a[0:3], v[68:71], a[148:151], a[0:3]
    v_exp_f32 v33, v33
    v_mfma_f32_16x16x32_bf16 a[4:7], v[76:79], a[148:151], a[4:7]
    ds_read_b128 a[132:135], v2 offset:53248
    v_cvt_pk_bf16_f32 v96, v32, v33
    v_mfma_f32_16x16x32_bf16 a[4:7], v[72:75], a[144:147], a[4:7]
    v_exp_f32 v34, v34
    v_mfma_f32_16x16x32_bf16 a[8:11], v[80:83], a[144:147], a[8:11]
    ds_read_b128 a[136:139], v3 offset:53248
    v_mfma_f32_16x16x32_bf16 a[8:11], v[84:87], a[148:151], a[8:11]
    v_exp_f32 v35, v35
    v_mfma_f32_16x16x32_bf16 a[12:15], v[92:95], a[148:151], a[12:15]
    ds_read_b128 a[140:143], v4 offset:53248
    v_cvt_pk_bf16_f32 v97, v34, v35
    v_mfma_f32_16x16x32_bf16 a[12:15], v[88:91], a[144:147], a[12:15]
    v_exp_f32 v36, v36
    v_mfma_f32_16x16x32_bf16 a[16:19], v[64:67], a[152:155], a[16:19]
    v_mfma_f32_16x16x32_bf16 a[16:19], v[68:71], a[156:159], a[16:19]
    v_exp_f32 v37, v37
    v_mfma_f32_16x16x32_bf16 a[20:23], v[76:79], a[156:159], a[20:23]
    v_cvt_pk_bf16_f32 v104, v36, v37
    v_mfma_f32_16x16x32_bf16 a[20:23], v[72:75], a[152:155], a[20:23]
    v_exp_f32 v38, v38
    v_mfma_f32_16x16x32_bf16 a[24:27], v[80:83], a[152:155], a[24:27]
    v_mfma_f32_16x16x32_bf16 a[24:27], v[84:87], a[156:159], a[24:27]
    v_exp_f32 v39, v39
    v_mfma_f32_16x16x32_bf16 a[28:31], v[92:95], a[156:159], a[28:31]
    v_cvt_pk_bf16_f32 v105, v38, v39
    v_mfma_f32_16x16x32_bf16 a[28:31], v[88:91], a[152:155], a[28:31]
    s_waitcnt lgkmcnt(0)
    v_mfma_f32_16x16x32_bf16 v[48:51], a[128:131], v[160:163], v[128:131]
    ds_read_b64_tr_b16 a[144:145], v7 offset:32768
    ds_read_b64_tr_b16 a[146:147], v7 offset:36864
    v_mfma_f32_16x16x32_bf16 v[48:51], a[132:135], v[164:167], v[48:51]
    v_exp_f32 v40, v40
    v_mfma_f32_16x16x32_bf16 v[48:51], a[136:139], v[168:171], v[48:51]
    ds_read_b64_tr_b16 a[148:149], v7 offset:40960
    ds_read_b64_tr_b16 a[150:151], v7 offset:45056
    v_mfma_f32_16x16x32_bf16 v[48:51], a[140:143], v[172:175], v[48:51]
    v_exp_f32 v41, v41
    v_mfma_f32_16x16x32_bf16 v[52:55], a[140:143], v[188:191], v[132:135]
    ds_read_b64_tr_b16 a[152:153], v8 offset:32768
    ds_read_b64_tr_b16 a[154:155], v8 offset:36864
    v_mfma_f32_16x16x32_bf16 v[52:55], a[136:139], v[184:187], v[52:55]
    v_exp_f32 v42, v42
    v_mfma_f32_16x16x32_bf16 v[52:55], a[132:135], v[180:183], v[52:55]
    ds_read_b64_tr_b16 a[156:157], v8 offset:40960
    ds_read_b64_tr_b16 a[158:159], v8 offset:45056
    v_mfma_f32_16x16x32_bf16 v[52:55], a[128:131], v[176:179], v[52:55]
    v_exp_f32 v43, v43
    v_mfma_f32_16x16x32_bf16 v[56:59], a[128:131], v[192:195], v[136:139]
    v_cvt_pk_bf16_f32 v112, v40, v41
    v_cvt_pk_bf16_f32 v113, v42, v43
    v_mfma_f32_16x16x32_bf16 v[56:59], a[132:135], v[196:199], v[56:59]
    v_exp_f32 v44, v44
    v_mfma_f32_16x16x32_bf16 v[56:59], a[136:139], v[200:203], v[56:59]
    v_mfma_f32_16x16x32_bf16 v[56:59], a[140:143], v[204:207], v[56:59]
    v_exp_f32 v45, v45
    v_mfma_f32_16x16x32_bf16 v[60:63], a[140:143], v[220:223], v[140:143]
    v_cvt_pk_bf16_f32 v120, v44, v45
    v_mfma_f32_16x16x32_bf16 v[60:63], a[136:139], v[216:219], v[60:63]
    v_exp_f32 v46, v46
    v_mfma_f32_16x16x32_bf16 v[60:63], a[132:135], v[212:215], v[60:63]
    v_mfma_f32_16x16x32_bf16 v[60:63], a[128:131], v[208:211], v[60:63]
    v_exp_f32 v47, v47
    v_mfma_f32_16x16x32_bf16 v[144:147], v[72:75], a[164:167], v[144:147]
    v_cvt_pk_bf16_f32 v121, v46, v47
    v_mfma_f32_16x16x32_bf16 v[144:147], v[76:79], a[164:167], v[144:147]
    s_waitcnt lgkmcnt(0)
    v_exp_f32 v48, v48
    v_mfma_f32_16x16x32_bf16 a[32:35], v[64:67], a[144:147], a[32:35]
    ds_read_b128 a[128:131], v1 offset:57344
    v_mfma_f32_16x16x32_bf16 a[32:35], v[68:71], a[148:151], a[32:35]
    v_exp_f32 v49, v49
    v_mfma_f32_16x16x32_bf16 a[36:39], v[76:79], a[148:151], a[36:39]
    ds_read_b128 a[132:135], v2 offset:57344
    v_cvt_pk_bf16_f32 v98, v48, v49
    v_mfma_f32_16x16x32_bf16 a[36:39], v[72:75], a[144:147], a[36:39]
    v_exp_f32 v50, v50
    v_mfma_f32_16x16x32_bf16 a[40:43], v[80:83], a[144:147], a[40:43]
    ds_read_b128 a[136:139], v3 offset:57344
    v_mfma_f32_16x16x32_bf16 a[40:43], v[84:87], a[148:151], a[40:43]
    v_exp_f32 v51, v51
    v_mfma_f32_16x16x32_bf16 a[44:47], v[92:95], a[148:151], a[44:47]
    ds_read_b128 a[140:143], v4 offset:57344
    v_cvt_pk_bf16_f32 v99, v50, v51
    v_mfma_f32_16x16x32_bf16 a[44:47], v[88:91], a[144:147], a[44:47]
    v_exp_f32 v52, v52
    v_mfma_f32_16x16x32_bf16 a[48:51], v[64:67], a[152:155], a[48:51]
    v_mfma_f32_16x16x32_bf16 a[48:51], v[68:71], a[156:159], a[48:51]
    v_exp_f32 v53, v53
    v_mfma_f32_16x16x32_bf16 a[52:55], v[76:79], a[156:159], a[52:55]
    v_cvt_pk_bf16_f32 v106, v52, v53
    v_mfma_f32_16x16x32_bf16 a[52:55], v[72:75], a[152:155], a[52:55]
    v_exp_f32 v54, v54
    v_mfma_f32_16x16x32_bf16 a[56:59], v[80:83], a[152:155], a[56:59]
    v_mfma_f32_16x16x32_bf16 a[56:59], v[84:87], a[156:159], a[56:59]
    v_exp_f32 v55, v55
    v_mfma_f32_16x16x32_bf16 a[60:63], v[92:95], a[156:159], a[60:63]
    v_cvt_pk_bf16_f32 v107, v54, v55
    v_mfma_f32_16x16x32_bf16 a[60:63], v[88:91], a[152:155], a[60:63]
    s_waitcnt lgkmcnt(0)
    v_mfma_f32_16x16x32_bf16 v[32:35], a[128:131], v[160:163], v[128:131]
    ds_read_b64_tr_b16 a[144:145], v9 offset:32768
    ds_read_b64_tr_b16 a[146:147], v9 offset:36864
    v_mfma_f32_16x16x32_bf16 v[32:35], a[132:135], v[164:167], v[32:35]
    v_exp_f32 v56, v56
    v_mfma_f32_16x16x32_bf16 v[32:35], a[136:139], v[168:171], v[32:35]
    ds_read_b64_tr_b16 a[148:149], v9 offset:40960
    ds_read_b64_tr_b16 a[150:151], v9 offset:45056
    v_mfma_f32_16x16x32_bf16 v[32:35], a[140:143], v[172:175], v[32:35]
    v_exp_f32 v57, v57
    v_mfma_f32_16x16x32_bf16 v[36:39], a[140:143], v[188:191], v[132:135]
    ds_read_b64_tr_b16 a[152:153], v10 offset:32768
    ds_read_b64_tr_b16 a[154:155], v10 offset:36864
    v_mfma_f32_16x16x32_bf16 v[36:39], a[136:139], v[184:187], v[36:39]
    v_exp_f32 v58, v58
    v_mfma_f32_16x16x32_bf16 v[36:39], a[132:135], v[180:183], v[36:39]
    ds_read_b64_tr_b16 a[156:157], v10 offset:40960
    ds_read_b64_tr_b16 a[158:159], v10 offset:45056
    v_mfma_f32_16x16x32_bf16 v[36:39], a[128:131], v[176:179], v[36:39]
    v_exp_f32 v59, v59
    v_mfma_f32_16x16x32_bf16 v[40:43], a[128:131], v[192:195], v[136:139]
    v_cvt_pk_bf16_f32 v114, v56, v57
    v_cvt_pk_bf16_f32 v115, v58, v59
    v_mfma_f32_16x16x32_bf16 v[40:43], a[132:135], v[196:199], v[40:43]
    v_exp_f32 v60, v60
    v_mfma_f32_16x16x32_bf16 v[40:43], a[136:139], v[200:203], v[40:43]
    v_mfma_f32_16x16x32_bf16 v[40:43], a[140:143], v[204:207], v[40:43]
    v_exp_f32 v61, v61
    v_mfma_f32_16x16x32_bf16 v[44:47], a[140:143], v[220:223], v[140:143]
    v_cvt_pk_bf16_f32 v122, v60, v61
    v_mfma_f32_16x16x32_bf16 v[44:47], a[136:139], v[216:219], v[44:47]
    v_exp_f32 v62, v62
    v_mfma_f32_16x16x32_bf16 v[44:47], a[132:135], v[212:215], v[44:47]
    v_mfma_f32_16x16x32_bf16 v[44:47], a[128:131], v[208:211], v[44:47]
    v_exp_f32 v63, v63
    v_mfma_f32_16x16x32_bf16 v[144:147], v[80:83], a[168:171], v[144:147]
    v_cvt_pk_bf16_f32 v123, v62, v63
    v_mfma_f32_16x16x32_bf16 v[144:147], v[84:87], a[168:171], v[144:147]
    s_waitcnt lgkmcnt(0)
    v_exp_f32 v32, v32
    v_mfma_f32_16x16x32_bf16 a[64:67], v[64:67], a[144:147], a[64:67]
    ds_read_b128 a[128:131], v1 offset:61440
    v_mfma_f32_16x16x32_bf16 a[64:67], v[68:71], a[148:151], a[64:67]
    v_exp_f32 v33, v33
    v_mfma_f32_16x16x32_bf16 a[68:71], v[76:79], a[148:151], a[68:71]
    ds_read_b128 a[132:135], v2 offset:61440
    v_cvt_pk_bf16_f32 v100, v32, v33
    v_mfma_f32_16x16x32_bf16 a[68:71], v[72:75], a[144:147], a[68:71]
    v_exp_f32 v34, v34
    v_mfma_f32_16x16x32_bf16 a[72:75], v[80:83], a[144:147], a[72:75]
    ds_read_b128 a[136:139], v3 offset:61440
    v_mfma_f32_16x16x32_bf16 a[72:75], v[84:87], a[148:151], a[72:75]
    v_exp_f32 v35, v35
    v_mfma_f32_16x16x32_bf16 a[76:79], v[92:95], a[148:151], a[76:79]
    ds_read_b128 a[140:143], v4 offset:61440
    v_cvt_pk_bf16_f32 v101, v34, v35
    v_mfma_f32_16x16x32_bf16 a[76:79], v[88:91], a[144:147], a[76:79]
    v_exp_f32 v36, v36
    v_mfma_f32_16x16x32_bf16 a[80:83], v[64:67], a[152:155], a[80:83]
    v_mfma_f32_16x16x32_bf16 a[80:83], v[68:71], a[156:159], a[80:83]
    v_exp_f32 v37, v37
    v_mfma_f32_16x16x32_bf16 a[84:87], v[76:79], a[156:159], a[84:87]
    v_cvt_pk_bf16_f32 v108, v36, v37
    v_mfma_f32_16x16x32_bf16 a[84:87], v[72:75], a[152:155], a[84:87]
    v_exp_f32 v38, v38
    v_mfma_f32_16x16x32_bf16 a[88:91], v[80:83], a[152:155], a[88:91]
    v_mfma_f32_16x16x32_bf16 a[88:91], v[84:87], a[156:159], a[88:91]
    v_exp_f32 v39, v39
    v_mfma_f32_16x16x32_bf16 a[92:95], v[92:95], a[156:159], a[92:95]
    v_cvt_pk_bf16_f32 v109, v38, v39
    v_mfma_f32_16x16x32_bf16 a[92:95], v[88:91], a[152:155], a[92:95]
    s_waitcnt lgkmcnt(0)
    v_mfma_f32_16x16x32_bf16 v[48:51], a[128:131], v[160:163], v[128:131]
    ds_read_b64_tr_b16 a[144:145], v11 offset:32768
    ds_read_b64_tr_b16 a[146:147], v11 offset:36864
    v_mfma_f32_16x16x32_bf16 v[48:51], a[132:135], v[164:167], v[48:51]
    v_exp_f32 v40, v40
    v_mfma_f32_16x16x32_bf16 v[48:51], a[136:139], v[168:171], v[48:51]
    ds_read_b64_tr_b16 a[148:149], v11 offset:40960
    ds_read_b64_tr_b16 a[150:151], v11 offset:45056
    v_mfma_f32_16x16x32_bf16 v[48:51], a[140:143], v[172:175], v[48:51]
    v_exp_f32 v41, v41
    v_mfma_f32_16x16x32_bf16 v[52:55], a[140:143], v[188:191], v[132:135]
    ds_read_b64_tr_b16 a[152:153], v12 offset:32768
    ds_read_b64_tr_b16 a[154:155], v12 offset:36864
    v_mfma_f32_16x16x32_bf16 v[52:55], a[136:139], v[184:187], v[52:55]
    v_exp_f32 v42, v42
    v_mfma_f32_16x16x32_bf16 v[52:55], a[132:135], v[180:183], v[52:55]
    ds_read_b64_tr_b16 a[156:157], v12 offset:40960
    ds_read_b64_tr_b16 a[158:159], v12 offset:45056
    v_mfma_f32_16x16x32_bf16 v[52:55], a[128:131], v[176:179], v[52:55]
    v_exp_f32 v43, v43
    v_mfma_f32_16x16x32_bf16 v[56:59], a[128:131], v[192:195], v[136:139]
    v_cvt_pk_bf16_f32 v116, v40, v41
    v_cvt_pk_bf16_f32 v117, v42, v43
    v_mfma_f32_16x16x32_bf16 v[56:59], a[132:135], v[196:199], v[56:59]
    v_exp_f32 v44, v44
    v_mfma_f32_16x16x32_bf16 v[56:59], a[136:139], v[200:203], v[56:59]
    v_mfma_f32_16x16x32_bf16 v[56:59], a[140:143], v[204:207], v[56:59]
    v_exp_f32 v45, v45
    v_mfma_f32_16x16x32_bf16 v[60:63], a[140:143], v[220:223], v[140:143]
    v_cvt_pk_bf16_f32 v124, v44, v45
    v_mfma_f32_16x16x32_bf16 v[60:63], a[136:139], v[216:219], v[60:63]
    v_exp_f32 v46, v46
    v_mfma_f32_16x16x32_bf16 v[60:63], a[132:135], v[212:215], v[60:63]
    v_mfma_f32_16x16x32_bf16 v[60:63], a[128:131], v[208:211], v[60:63]
    v_exp_f32 v47, v47
    v_mfma_f32_16x16x32_bf16 v[144:147], v[88:91], a[172:175], v[144:147]
    v_cvt_pk_bf16_f32 v125, v46, v47
    v_mfma_f32_16x16x32_bf16 v[144:147], v[92:95], a[172:175], v[144:147]
    s_waitcnt vmcnt(0) lgkmcnt(0)
    v_exp_f32 v48, v48
    v_mfma_f32_16x16x32_bf16 a[96:99], v[64:67], a[144:147], a[96:99]
    s_barrier
    ds_read_b64_tr_b16 v[160:161], v5 offset:49152
    v_mfma_f32_16x16x32_bf16 a[96:99], v[68:71], a[148:151], a[96:99]
    v_exp_f32 v49, v49
    v_mfma_f32_16x16x32_bf16 a[100:103], v[76:79], a[148:151], a[100:103]
    ds_read_b64_tr_b16 v[162:163], v5 offset:53248
    v_cvt_pk_bf16_f32 v102, v48, v49
    v_mfma_f32_16x16x32_bf16 a[100:103], v[72:75], a[144:147], a[100:103]
    v_exp_f32 v50, v50
    v_mfma_f32_16x16x32_bf16 a[104:107], v[80:83], a[144:147], a[104:107]
    ds_read_b64_tr_b16 v[164:165], v5 offset:57344
    ds_read_b64_tr_b16 v[166:167], v5 offset:61440
    v_mfma_f32_16x16x32_bf16 a[104:107], v[84:87], a[148:151], a[104:107]
    v_exp_f32 v51, v51
    v_mfma_f32_16x16x32_bf16 a[108:111], v[92:95], a[148:151], a[108:111]
    ds_read_b64_tr_b16 v[168:169], v6 offset:49152
    v_cvt_pk_bf16_f32 v103, v50, v51
    v_mfma_f32_16x16x32_bf16 a[108:111], v[88:91], a[144:147], a[108:111]
    v_exp_f32 v52, v52
    v_mfma_f32_16x16x32_bf16 a[112:115], v[64:67], a[152:155], a[112:115]
    ds_read_b64_tr_b16 v[170:171], v6 offset:53248
    ds_read_b64_tr_b16 v[172:173], v6 offset:57344
    v_mfma_f32_16x16x32_bf16 a[112:115], v[68:71], a[156:159], a[112:115]
    v_exp_f32 v53, v53
    v_mfma_f32_16x16x32_bf16 a[116:119], v[76:79], a[156:159], a[116:119]
    ds_read_b64_tr_b16 v[174:175], v6 offset:61440
    v_cvt_pk_bf16_f32 v110, v52, v53
    v_mfma_f32_16x16x32_bf16 a[116:119], v[72:75], a[152:155], a[116:119]
    v_exp_f32 v54, v54
    v_mfma_f32_16x16x32_bf16 a[120:123], v[80:83], a[152:155], a[120:123]
    ds_read_b64_tr_b16 v[176:177], v7 offset:49152
    ds_read_b64_tr_b16 v[178:179], v7 offset:53248
    v_mfma_f32_16x16x32_bf16 a[120:123], v[84:87], a[156:159], a[120:123]
    v_exp_f32 v55, v55
    v_mfma_f32_16x16x32_bf16 a[124:127], v[92:95], a[156:159], a[124:127]
    ds_read_b64_tr_b16 v[180:181], v7 offset:57344
    v_cvt_pk_bf16_f32 v111, v54, v55
    v_mfma_f32_16x16x32_bf16 a[124:127], v[88:91], a[152:155], a[124:127]
    ds_read_b64_tr_b16 v[182:183], v7 offset:61440
L_tail:
    s_waitcnt lgkmcnt(8)
    v_mfma_f32_16x16x32_bf16 a[0:3], v[96:99], v[160:163], a[0:3]
    ds_read_b64_tr_b16 v[184:185], v8 offset:49152
    ds_read_b64_tr_b16 v[186:187], v8 offset:53248
    v_mfma_f32_16x16x32_bf16 a[0:3], v[100:103], v[164:167], a[0:3]
    v_exp_f32 v56, v56
    s_waitcnt lgkmcnt(6)
    v_mfma_f32_16x16x32_bf16 a[16:19], v[100:103], v[172:175], a[16:19]
    ds_read_b64_tr_b16 v[188:189], v8 offset:57344
    ds_read_b64_tr_b16 v[190:191], v8 offset:61440
    v_mfma_f32_16x16x32_bf16 a[16:19], v[96:99], v[168:171], a[16:19]
    v_exp_f32 v57, v57
    v_mfma_f32_16x16x32_bf16 v[144:147], v[96:99], a[160:163], v[144:147]
    ds_read_b64_tr_b16 v[192:193], v9 offset:49152
    ds_read_b64_tr_b16 v[194:195], v9 offset:53248
    v_mfma_f32_16x16x32_bf16 v[144:147], v[100:103], a[160:163], v[144:147]
    v_exp_f32 v58, v58
    s_waitcnt lgkmcnt(6)
    v_mfma_f32_16x16x32_bf16 a[32:35], v[96:99], v[176:179], a[32:35]
    ds_read_b64_tr_b16 v[196:197], v9 offset:57344
    ds_read_b64_tr_b16 v[198:199], v9 offset:61440
    v_mfma_f32_16x16x32_bf16 a[32:35], v[100:103], v[180:183], a[32:35]
    v_exp_f32 v59, v59
    v_mfma_f32_16x16x32_bf16 v[144:147], v[104:107], a[164:167], v[144:147]
    ds_read_b64_tr_b16 v[200:201], v10 offset:49152
    ds_read_b64_tr_b16 v[202:203], v10 offset:53248
    v_mfma_f32_16x16x32_bf16 v[144:147], v[108:111], a[164:167], v[144:147]
    v_exp_f32 v60, v60
    v_mfma_f32_16x16x32_bf16 v[144:147], v[112:115], a[168:171], v[144:147]
    ds_read_b64_tr_b16 v[204:205], v10 offset:57344
    ds_read_b64_tr_b16 v[206:207], v10 offset:61440
    v_mfma_f32_16x16x32_bf16 v[144:147], v[120:123], a[172:175], v[144:147]
    v_exp_f32 v61, v61
    v_exp_f32 v62, v62
    s_waitcnt lgkmcnt(8)
    v_mfma_f32_16x16x32_bf16 a[48:51], v[100:103], v[188:191], a[48:51]
    ds_read_b64_tr_b16 v[208:209], v11 offset:49152
    ds_read_b64_tr_b16 v[210:211], v11 offset:53248
    v_mfma_f32_16x16x32_bf16 a[48:51], v[96:99], v[184:187], a[48:51]
    v_exp_f32 v63, v63
    s_waitcnt lgkmcnt(6)
    v_mfma_f32_16x16x32_bf16 a[64:67], v[96:99], v[192:195], a[64:67]
    ds_read_b64_tr_b16 v[212:213], v11 offset:57344
    ds_read_b64_tr_b16 v[214:215], v11 offset:61440
    v_mfma_f32_16x16x32_bf16 a[64:67], v[100:103], v[196:199], a[64:67]
    v_cvt_pk_bf16_f32 v118, v56, v57
    v_cvt_pk_bf16_f32 v119, v58, v59
    s_waitcnt lgkmcnt(4)
    v_mfma_f32_16x16x32_bf16 a[80:83], v[100:103], v[204:207], a[80:83]
    ds_read_b64_tr_b16 v[216:217], v12 offset:49152
    ds_read_b64_tr_b16 v[218:219], v12 offset:53248
    v_mfma_f32_16x16x32_bf16 a[80:83], v[96:99], v[200:203], a[80:83]
    v_cvt_pk_bf16_f32 v126, v60, v61
    v_cvt_pk_bf16_f32 v127, v62, v63
    v_mfma_f32_16x16x32_bf16 v[144:147], v[116:119], a[168:171], v[144:147]
    ds_read_b64_tr_b16 v[220:221], v12 offset:57344
    ds_read_b64_tr_b16 v[222:223], v12 offset:61440
    v_mfma_f32_16x16x32_bf16 v[144:147], v[124:127], a[172:175], v[144:147]
    s_waitcnt lgkmcnt(4)
    v_mfma_f32_16x16x32_bf16 a[96:99], v[96:99], v[208:211], a[96:99]
    v_mfma_f32_16x16x32_bf16 a[96:99], v[100:103], v[212:215], a[96:99]
    s_waitcnt lgkmcnt(0)
    v_mfma_f32_16x16x32_bf16 a[112:115], v[100:103], v[220:223], a[112:115]
    v_mfma_f32_16x16x32_bf16 a[112:115], v[96:99], v[216:219], a[112:115]
    s_nop 1
    v_rcp_f32 v28, v144
    v_rcp_f32 v29, v145
    v_rcp_f32 v30, v146
    v_rcp_f32 v31, v147
    v_mfma_f32_16x16x32_bf16 a[4:7], v[104:107], v[160:163], a[4:7]
    v_mov_b32_dpp v20, v28 quad_perm:[0,0,0,0] row_mask:0xf bank_mask:0xf
    v_mov_b32_dpp v21, v29 quad_perm:[0,0,0,0] row_mask:0xf bank_mask:0xf
    v_mov_b32_dpp v22, v30 quad_perm:[0,0,0,0] row_mask:0xf bank_mask:0xf
    v_mov_b32_dpp v23, v31 quad_perm:[0,0,0,0] row_mask:0xf bank_mask:0xf
    v_accvgpr_read_b32 v32, a0
    v_accvgpr_read_b32 v33, a16
    v_mfma_f32_16x16x32_bf16 a[4:7], v[108:111], v[164:167], a[4:7]
    v_accvgpr_read_b32 v34, a32
    v_accvgpr_read_b32 v35, a48
    v_accvgpr_read_b32 v36, a64
    v_accvgpr_read_b32 v37, a80
    v_accvgpr_read_b32 v38, a96
    v_accvgpr_read_b32 v39, a112
    v_mfma_f32_16x16x32_bf16 a[20:23], v[108:111], v[172:175], a[20:23]
    v_mul_f32 v32, v32, v20
    v_mul_f32 v33, v33, v20
    v_mul_f32 v34, v34, v20
    v_mul_f32 v35, v35, v20
    v_mul_f32 v36, v36, v20
    v_mul_f32 v37, v37, v20
    v_mfma_f32_16x16x32_bf16 a[20:23], v[104:107], v[168:171], a[20:23]
    v_mul_f32 v38, v38, v20
    v_mul_f32 v39, v39, v20
    v_cvt_pk_bf16_f32 v32, v32, v33
    v_cvt_pk_bf16_f32 v33, v34, v35
    v_cvt_pk_bf16_f32 v34, v36, v37
    v_cvt_pk_bf16_f32 v35, v38, v39
    v_mfma_f32_16x16x32_bf16 a[36:39], v[104:107], v[176:179], a[36:39]
    ds_write_b128 v148, v[32:35] offset:0
    ds_read_b64_tr_b16 v[128:129], v150 offset:0
    ds_read_b64_tr_b16 v[130:131], v151 offset:0
    v_accvgpr_read_b32 v40, a1
    v_accvgpr_read_b32 v41, a17
    v_accvgpr_read_b32 v42, a33
    v_mfma_f32_16x16x32_bf16 a[36:39], v[108:111], v[180:183], a[36:39]
    v_accvgpr_read_b32 v43, a49
    v_accvgpr_read_b32 v44, a65
    v_accvgpr_read_b32 v45, a81
    v_accvgpr_read_b32 v46, a97
    v_accvgpr_read_b32 v47, a113
    v_mul_f32 v40, v40, v21
    v_mfma_f32_16x16x32_bf16 a[52:55], v[108:111], v[188:191], a[52:55]
    v_mul_f32 v41, v41, v21
    v_mul_f32 v42, v42, v21
    v_mul_f32 v43, v43, v21
    v_mul_f32 v44, v44, v21
    v_mul_f32 v45, v45, v21
    v_mul_f32 v46, v46, v21
    v_mfma_f32_16x16x32_bf16 a[52:55], v[104:107], v[184:187], a[52:55]
    v_mul_f32 v47, v47, v21
    v_cvt_pk_bf16_f32 v40, v40, v41
    v_cvt_pk_bf16_f32 v41, v42, v43
    v_cvt_pk_bf16_f32 v42, v44, v45
    v_cvt_pk_bf16_f32 v43, v46, v47
    s_waitcnt lgkmcnt(0)
    v_mfma_f32_16x16x32_bf16 a[68:71], v[104:107], v[192:195], a[68:71]
    buffer_store_dwordx4 v[128:131], v152, s[20:23], s36 offen offset:0 sc0 sc1
    ds_write_b128 v148, v[40:43] offset:256
    ds_read_b64_tr_b16 v[132:133], v150 offset:256
    ds_read_b64_tr_b16 v[134:135], v151 offset:256
    v_accvgpr_read_b32 v48, a2
    v_accvgpr_read_b32 v49, a18
    v_mfma_f32_16x16x32_bf16 a[68:71], v[108:111], v[196:199], a[68:71]
    v_accvgpr_read_b32 v50, a34
    v_accvgpr_read_b32 v51, a50
    v_accvgpr_read_b32 v52, a66
    v_accvgpr_read_b32 v53, a82
    v_accvgpr_read_b32 v54, a98
    v_accvgpr_read_b32 v55, a114
    v_mfma_f32_16x16x32_bf16 a[84:87], v[108:111], v[204:207], a[84:87]
    v_mul_f32 v48, v48, v22
    v_mul_f32 v49, v49, v22
    v_mul_f32 v50, v50, v22
    v_mul_f32 v51, v51, v22
    v_mul_f32 v52, v52, v22
    v_mul_f32 v53, v53, v22
    v_mfma_f32_16x16x32_bf16 a[84:87], v[104:107], v[200:203], a[84:87]
    v_mul_f32 v54, v54, v22
    v_mul_f32 v55, v55, v22
    v_cvt_pk_bf16_f32 v48, v48, v49
    v_cvt_pk_bf16_f32 v49, v50, v51
    v_cvt_pk_bf16_f32 v50, v52, v53
    v_cvt_pk_bf16_f32 v51, v54, v55
    v_mfma_f32_16x16x32_bf16 a[100:103], v[104:107], v[208:211], a[100:103]
    s_waitcnt lgkmcnt(0)
    buffer_store_dwordx4 v[132:135], v152, s[20:23], s36 offen offset:256 sc0 sc1
    ds_write_b128 v148, v[48:51] offset:512
    ds_read_b64_tr_b16 v[136:137], v150 offset:512
    ds_read_b64_tr_b16 v[138:139], v151 offset:512
    v_accvgpr_read_b32 v56, a3
    v_mfma_f32_16x16x32_bf16 a[100:103], v[108:111], v[212:215], a[100:103]
    v_accvgpr_read_b32 v57, a19
    v_accvgpr_read_b32 v58, a35
    v_accvgpr_read_b32 v59, a51
    v_accvgpr_read_b32 v60, a67
    v_accvgpr_read_b32 v61, a83
    v_accvgpr_read_b32 v62, a99
    v_mfma_f32_16x16x32_bf16 a[116:119], v[108:111], v[220:223], a[116:119]
    v_accvgpr_read_b32 v63, a115
    v_mul_f32 v56, v56, v23
    v_mul_f32 v57, v57, v23
    v_mul_f32 v58, v58, v23
    v_mul_f32 v59, v59, v23
    v_mul_f32 v60, v60, v23
    v_mfma_f32_16x16x32_bf16 a[116:119], v[104:107], v[216:219], a[116:119]
    v_mul_f32 v61, v61, v23
    v_mul_f32 v62, v62, v23
    v_mul_f32 v63, v63, v23
    v_cvt_pk_bf16_f32 v56, v56, v57
    v_cvt_pk_bf16_f32 v57, v58, v59
    v_cvt_pk_bf16_f32 v58, v60, v61
    v_mfma_f32_16x16x32_bf16 a[8:11], v[112:115], v[160:163], a[8:11]
    v_cvt_pk_bf16_f32 v59, v62, v63
    s_waitcnt lgkmcnt(0)
    buffer_store_dwordx4 v[136:139], v152, s[20:23], s36 offen offset:512 sc0 sc1
    ds_write_b128 v148, v[56:59] offset:768
    ds_read_b64_tr_b16 v[140:141], v150 offset:768
    ds_read_b64_tr_b16 v[142:143], v151 offset:768
    v_mfma_f32_16x16x32_bf16 a[8:11], v[116:119], v[164:167], a[8:11]
    v_mov_b32_dpp v24, v28 quad_perm:[1,1,1,1] row_mask:0xf bank_mask:0xf
    v_mov_b32_dpp v25, v29 quad_perm:[1,1,1,1] row_mask:0xf bank_mask:0xf
    v_mov_b32_dpp v26, v30 quad_perm:[1,1,1,1] row_mask:0xf bank_mask:0xf
    v_mov_b32_dpp v27, v31 quad_perm:[1,1,1,1] row_mask:0xf bank_mask:0xf
    v_accvgpr_read_b32 v64, a4
    v_accvgpr_read_b32 v65, a20
    v_mfma_f32_16x16x32_bf16 a[24:27], v[116:119], v[172:175], a[24:27]
    v_accvgpr_read_b32 v66, a36
    v_accvgpr_read_b32 v67, a52
    v_accvgpr_read_b32 v68, a68
    v_accvgpr_read_b32 v69, a84
    v_accvgpr_read_b32 v70, a100
    v_accvgpr_read_b32 v71, a116
    v_mfma_f32_16x16x32_bf16 a[24:27], v[112:115], v[168:171], a[24:27]
    v_mul_f32 v64, v64, v24
    v_mul_f32 v65, v65, v24
    v_mul_f32 v66, v66, v24
    v_mul_f32 v67, v67, v24
    v_mul_f32 v68, v68, v24
    v_mul_f32 v69, v69, v24
    v_mfma_f32_16x16x32_bf16 a[40:43], v[112:115], v[176:179], a[40:43]
    v_mul_f32 v70, v70, v24
    v_mul_f32 v71, v71, v24
    v_cvt_pk_bf16_f32 v64, v64, v65
    v_cvt_pk_bf16_f32 v65, v66, v67
    v_cvt_pk_bf16_f32 v66, v68, v69
    v_cvt_pk_bf16_f32 v67, v70, v71
    v_mfma_f32_16x16x32_bf16 a[40:43], v[116:119], v[180:183], a[40:43]
    s_waitcnt lgkmcnt(0)
    buffer_store_dwordx4 v[140:143], v152, s[20:23], s36 offen offset:768 sc0 sc1
    ds_write_b128 v148, v[64:67] offset:4096
    ds_read_b64_tr_b16 v[128:129], v150 offset:4096
    ds_read_b64_tr_b16 v[130:131], v151 offset:4096
    v_accvgpr_read_b32 v72, a5
    v_mfma_f32_16x16x32_bf16 a[56:59], v[116:119], v[188:191], a[56:59]
    v_accvgpr_read_b32 v73, a21
    v_accvgpr_read_b32 v74, a37
    v_accvgpr_read_b32 v75, a53
    v_accvgpr_read_b32 v76, a69
    v_accvgpr_read_b32 v77, a85
    v_accvgpr_read_b32 v78, a101
    v_mfma_f32_16x16x32_bf16 a[56:59], v[112:115], v[184:187], a[56:59]
    v_accvgpr_read_b32 v79, a117
    v_mul_f32 v72, v72, v25
    v_mul_f32 v73, v73, v25
    v_mul_f32 v74, v74, v25
    v_mul_f32 v75, v75, v25
    v_mul_f32 v76, v76, v25
    v_mfma_f32_16x16x32_bf16 a[72:75], v[112:115], v[192:195], a[72:75]
    v_mul_f32 v77, v77, v25
    v_mul_f32 v78, v78, v25
    v_mul_f32 v79, v79, v25
    v_cvt_pk_bf16_f32 v72, v72, v73
    v_cvt_pk_bf16_f32 v73, v74, v75
    v_cvt_pk_bf16_f32 v74, v76, v77
    v_mfma_f32_16x16x32_bf16 a[72:75], v[116:119], v[196:199], a[72:75]
    v_cvt_pk_bf16_f32 v75, v78, v79
    s_waitcnt lgkmcnt(0)
    buffer_store_dwordx4 v[128:131], v152, s[20:23], s37 offen offset:0 sc0 sc1
    ds_write_b128 v148, v[72:75] offset:4352
    ds_read_b64_tr_b16 v[132:133], v150 offset:4352
    ds_read_b64_tr_b16 v[134:135], v151 offset:4352
    v_mfma_f32_16x16x32_bf16 a[88:91], v[116:119], v[204:207], a[88:91]
    v_accvgpr_read_b32 v80, a6
    v_accvgpr_read_b32 v81, a22
    v_accvgpr_read_b32 v82, a38
    v_accvgpr_read_b32 v83, a54
    v_accvgpr_read_b32 v84, a70
    v_accvgpr_read_b32 v85, a86
    v_mfma_f32_16x16x32_bf16 a[88:91], v[112:115], v[200:203], a[88:91]
    v_accvgpr_read_b32 v86, a102
    v_accvgpr_read_b32 v87, a118
    v_mul_f32 v80, v80, v26
    v_mul_f32 v81, v81, v26
    v_mul_f32 v82, v82, v26
    v_mul_f32 v83, v83, v26
    v_mfma_f32_16x16x32_bf16 a[104:107], v[112:115], v[208:211], a[104:107]
    v_mul_f32 v84, v84, v26
    v_mul_f32 v85, v85, v26
    v_mul_f32 v86, v86, v26
    v_mul_f32 v87, v87, v26
    v_cvt_pk_bf16_f32 v80, v80, v81
    v_cvt_pk_bf16_f32 v81, v82, v83
    v_mfma_f32_16x16x32_bf16 a[104:107], v[116:119], v[212:215], a[104:107]
    v_cvt_pk_bf16_f32 v82, v84, v85
    v_cvt_pk_bf16_f32 v83, v86, v87
    s_waitcnt lgkmcnt(0)
    buffer_store_dwordx4 v[132:135], v152, s[20:23], s37 offen offset:256 sc0 sc1
    ds_write_b128 v148, v[80:83] offset:4608
    ds_read_b64_tr_b16 v[136:137], v150 offset:4608
    v_mfma_f32_16x16x32_bf16 a[120:123], v[116:119], v[220:223], a[120:123]
    ds_read_b64_tr_b16 v[138:139], v151 offset:4608
    v_accvgpr_read_b32 v88, a7
    v_accvgpr_read_b32 v89, a23
    v_accvgpr_read_b32 v90, a39
    v_accvgpr_read_b32 v91, a55
    v_accvgpr_read_b32 v92, a71
    v_mfma_f32_16x16x32_bf16 a[120:123], v[112:115], v[216:219], a[120:123]
    v_accvgpr_read_b32 v93, a87
    v_accvgpr_read_b32 v94, a103
    v_accvgpr_read_b32 v95, a119
    v_mul_f32 v88, v88, v27
    v_mul_f32 v89, v89, v27
    v_mul_f32 v90, v90, v27
    v_mfma_f32_16x16x32_bf16 a[12:15], v[120:123], v[160:163], a[12:15]
    v_mul_f32 v91, v91, v27
    v_mul_f32 v92, v92, v27
    v_mul_f32 v93, v93, v27
    v_mul_f32 v94, v94, v27
    v_mul_f32 v95, v95, v27
    v_cvt_pk_bf16_f32 v88, v88, v89
    v_mfma_f32_16x16x32_bf16 a[12:15], v[124:127], v[164:167], a[12:15]
    v_cvt_pk_bf16_f32 v89, v90, v91
    v_cvt_pk_bf16_f32 v90, v92, v93
    v_cvt_pk_bf16_f32 v91, v94, v95
    s_waitcnt lgkmcnt(0)
    buffer_store_dwordx4 v[136:139], v152, s[20:23], s37 offen offset:512 sc0 sc1
    ds_write_b128 v148, v[88:91] offset:4864
    v_mfma_f32_16x16x32_bf16 a[28:31], v[124:127], v[172:175], a[28:31]
    ds_read_b64_tr_b16 v[140:141], v150 offset:4864
    ds_read_b64_tr_b16 v[142:143], v151 offset:4864
    v_mov_b32_dpp v20, v28 quad_perm:[2,2,2,2] row_mask:0xf bank_mask:0xf
    v_mov_b32_dpp v21, v29 quad_perm:[2,2,2,2] row_mask:0xf bank_mask:0xf
    v_mov_b32_dpp v22, v30 quad_perm:[2,2,2,2] row_mask:0xf bank_mask:0xf
    v_mov_b32_dpp v23, v31 quad_perm:[2,2,2,2] row_mask:0xf bank_mask:0xf
    v_mfma_f32_16x16x32_bf16 a[28:31], v[120:123], v[168:171], a[28:31]
    v_accvgpr_read_b32 v32, a8
    v_accvgpr_read_b32 v33, a24
    v_accvgpr_read_b32 v34, a40
    v_accvgpr_read_b32 v35, a56
    v_accvgpr_read_b32 v36, a72
    v_accvgpr_read_b32 v37, a88
    v_mfma_f32_16x16x32_bf16 a[44:47], v[120:123], v[176:179], a[44:47]
    v_accvgpr_read_b32 v38, a104
    v_accvgpr_read_b32 v39, a120
    v_mul_f32 v32, v32, v20
    v_mul_f32 v33, v33, v20
    v_mul_f32 v34, v34, v20
    v_mul_f32 v35, v35, v20
    v_mfma_f32_16x16x32_bf16 a[44:47], v[124:127], v[180:183], a[44:47]
    v_mul_f32 v36, v36, v20
    v_mul_f32 v37, v37, v20
    v_mul_f32 v38, v38, v20
    v_mul_f32 v39, v39, v20
    v_cvt_pk_bf16_f32 v32, v32, v33
    v_cvt_pk_bf16_f32 v33, v34, v35
    v_mfma_f32_16x16x32_bf16 a[60:63], v[124:127], v[188:191], a[60:63]
    v_cvt_pk_bf16_f32 v34, v36, v37
    v_cvt_pk_bf16_f32 v35, v38, v39
    s_waitcnt lgkmcnt(0)
    buffer_store_dwordx4 v[140:143], v152, s[20:23], s37 offen offset:768 sc0 sc1
    ds_write_b128 v148, v[32:35] offset:0
    ds_read_b64_tr_b16 v[128:129], v150 offset:0
    v_mfma_f32_16x16x32_bf16 a[60:63], v[120:123], v[184:187], a[60:63]
    ds_read_b64_tr_b16 v[130:131], v151 offset:0
    v_accvgpr_read_b32 v40, a9
    v_accvgpr_read_b32 v41, a25
    v_accvgpr_read_b32 v42, a41
    v_accvgpr_read_b32 v43, a57
    v_accvgpr_read_b32 v44, a73
    v_mfma_f32_16x16x32_bf16 a[76:79], v[120:123], v[192:195], a[76:79]
    v_accvgpr_read_b32 v45, a89
    v_accvgpr_read_b32 v46, a105
    v_accvgpr_read_b32 v47, a121
    v_mul_f32 v40, v40, v21
    v_mul_f32 v41, v41, v21
    v_mul_f32 v42, v42, v21
    v_mfma_f32_16x16x32_bf16 a[76:79], v[124:127], v[196:199], a[76:79]
    v_mul_f32 v43, v43, v21
    v_mul_f32 v44, v44, v21
    v_mul_f32 v45, v45, v21
    v_mul_f32 v46, v46, v21
    v_mul_f32 v47, v47, v21
    v_cvt_pk_bf16_f32 v40, v40, v41
    v_mfma_f32_16x16x32_bf16 a[92:95], v[124:127], v[204:207], a[92:95]
    v_cvt_pk_bf16_f32 v41, v42, v43
    v_cvt_pk_bf16_f32 v42, v44, v45
    v_cvt_pk_bf16_f32 v43, v46, v47
    s_waitcnt lgkmcnt(0)
    buffer_store_dwordx4 v[128:131], v152, s[20:23], s38 offen offset:0 sc0 sc1
    ds_write_b128 v148, v[40:43] offset:256
    v_mfma_f32_16x16x32_bf16 a[92:95], v[120:123], v[200:203], a[92:95]
    ds_read_b64_tr_b16 v[132:133], v150 offset:256
    ds_read_b64_tr_b16 v[134:135], v151 offset:256
    v_accvgpr_read_b32 v48, a10
    v_accvgpr_read_b32 v49, a26
    v_accvgpr_read_b32 v50, a42
    v_accvgpr_read_b32 v51, a58
    v_mfma_f32_16x16x32_bf16 a[108:111], v[120:123], v[208:211], a[108:111]
    v_accvgpr_read_b32 v52, a74
    v_accvgpr_read_b32 v53, a90
    v_accvgpr_read_b32 v54, a106
    v_accvgpr_read_b32 v55, a122
    v_mul_f32 v48, v48, v22
    v_mul_f32 v49, v49, v22
    v_mfma_f32_16x16x32_bf16 a[108:111], v[124:127], v[212:215], a[108:111]
    v_mul_f32 v50, v50, v22
    v_mul_f32 v51, v51, v22
    v_mul_f32 v52, v52, v22
    v_mul_f32 v53, v53, v22
    v_mul_f32 v54, v54, v22
    v_mul_f32 v55, v55, v22
    v_mfma_f32_16x16x32_bf16 a[124:127], v[124:127], v[220:223], a[124:127]
    v_cvt_pk_bf16_f32 v48, v48, v49
    v_cvt_pk_bf16_f32 v49, v50, v51
    v_cvt_pk_bf16_f32 v50, v52, v53
    v_cvt_pk_bf16_f32 v51, v54, v55
    s_waitcnt lgkmcnt(0)
    buffer_store_dwordx4 v[132:135], v152, s[20:23], s38 offen offset:256 sc0 sc1
    v_mfma_f32_16x16x32_bf16 a[124:127], v[120:123], v[216:219], a[124:127]
    ds_write_b128 v148, v[48:51] offset:512
    ds_read_b64_tr_b16 v[136:137], v150 offset:512
    ds_read_b64_tr_b16 v[138:139], v151 offset:512
    v_accvgpr_read_b32 v56, a11
    v_accvgpr_read_b32 v57, a27
    v_accvgpr_read_b32 v58, a43
    v_accvgpr_read_b32 v59, a59
    v_accvgpr_read_b32 v60, a75
    v_accvgpr_read_b32 v61, a91
    v_accvgpr_read_b32 v62, a107
    v_accvgpr_read_b32 v63, a123
    v_mul_f32 v56, v56, v23
    v_mul_f32 v57, v57, v23
    v_mul_f32 v58, v58, v23
    v_mul_f32 v59, v59, v23
    v_mul_f32 v60, v60, v23
    v_mul_f32 v61, v61, v23
    v_mul_f32 v62, v62, v23
    v_mul_f32 v63, v63, v23
    v_cvt_pk_bf16_f32 v56, v56, v57
    v_cvt_pk_bf16_f32 v57, v58, v59
    v_cvt_pk_bf16_f32 v58, v60, v61
    v_cvt_pk_bf16_f32 v59, v62, v63
    s_waitcnt lgkmcnt(0)
    buffer_store_dwordx4 v[136:139], v152, s[20:23], s38 offen offset:512 sc0 sc1
    ds_write_b128 v148, v[56:59] offset:768
    ds_read_b64_tr_b16 v[140:141], v150 offset:768
    ds_read_b64_tr_b16 v[142:143], v151 offset:768
    v_mov_b32_dpp v24, v28 quad_perm:[3,3,3,3] row_mask:0xf bank_mask:0xf
    v_mov_b32_dpp v25, v29 quad_perm:[3,3,3,3] row_mask:0xf bank_mask:0xf
    v_mov_b32_dpp v26, v30 quad_perm:[3,3,3,3] row_mask:0xf bank_mask:0xf
    v_mov_b32_dpp v27, v31 quad_perm:[3,3,3,3] row_mask:0xf bank_mask:0xf
    v_accvgpr_read_b32 v64, a12
    v_accvgpr_read_b32 v65, a28
    v_accvgpr_read_b32 v66, a44
    v_accvgpr_read_b32 v67, a60
    v_accvgpr_read_b32 v68, a76
    v_accvgpr_read_b32 v69, a92
    v_accvgpr_read_b32 v70, a108
    v_accvgpr_read_b32 v71, a124
    v_pk_mul_f32 v[64:65], v[64:65], v[24:25] op_sel:[0,0] op_sel_hi:[1,0]
    v_pk_mul_f32 v[66:67], v[66:67], v[24:25] op_sel:[0,0] op_sel_hi:[1,0]
    v_pk_mul_f32 v[68:69], v[68:69], v[24:25] op_sel:[0,0] op_sel_hi:[1,0]
    v_pk_mul_f32 v[70:71], v[70:71], v[24:25] op_sel:[0,0] op_sel_hi:[1,0]
    v_cvt_pk_bf16_f32 v64, v64, v65
    v_cvt_pk_bf16_f32 v65, v66, v67
    v_cvt_pk_bf16_f32 v66, v68, v69
    v_cvt_pk_bf16_f32 v67, v70, v71
    s_waitcnt lgkmcnt(0)
    buffer_store_dwordx4 v[140:143], v152, s[20:23], s38 offen offset:768 sc0 sc1
    ds_write_b128 v148, v[64:67] offset:4096
    ds_read_b64_tr_b16 v[128:129], v150 offset:4096
    ds_read_b64_tr_b16 v[130:131], v151 offset:4096
    v_accvgpr_read_b32 v72, a13
    v_accvgpr_read_b32 v73, a29
    v_accvgpr_read_b32 v74, a45
    v_accvgpr_read_b32 v75, a61
    v_accvgpr_read_b32 v76, a77
    v_accvgpr_read_b32 v77, a93
    v_accvgpr_read_b32 v78, a109
    v_accvgpr_read_b32 v79, a125
    v_pk_mul_f32 v[72:73], v[72:73], v[24:25] op_sel:[0,1] op_sel_hi:[1,1]
    v_pk_mul_f32 v[74:75], v[74:75], v[24:25] op_sel:[0,1] op_sel_hi:[1,1]
    v_pk_mul_f32 v[76:77], v[76:77], v[24:25] op_sel:[0,1] op_sel_hi:[1,1]
    v_pk_mul_f32 v[78:79], v[78:79], v[24:25] op_sel:[0,1] op_sel_hi:[1,1]
    v_cvt_pk_bf16_f32 v72, v72, v73
    v_cvt_pk_bf16_f32 v73, v74, v75
    v_cvt_pk_bf16_f32 v74, v76, v77
    v_cvt_pk_bf16_f32 v75, v78, v79
    s_waitcnt lgkmcnt(0)
    buffer_store_dwordx4 v[128:131], v152, s[20:23], s39 offen offset:0 sc0 sc1
    ds_write_b128 v148, v[72:75] offset:4352
    ds_read_b64_tr_b16 v[132:133], v150 offset:4352
    ds_read_b64_tr_b16 v[134:135], v151 offset:4352
    v_accvgpr_read_b32 v80, a14
    v_accvgpr_read_b32 v81, a30
    v_accvgpr_read_b32 v82, a46
    v_accvgpr_read_b32 v83, a62
    v_accvgpr_read_b32 v84, a78
    v_accvgpr_read_b32 v85, a94
    v_accvgpr_read_b32 v86, a110
    v_accvgpr_read_b32 v87, a126
    v_pk_mul_f32 v[80:81], v[80:81], v[26:27] op_sel:[0,0] op_sel_hi:[1,0]
    v_pk_mul_f32 v[82:83], v[82:83], v[26:27] op_sel:[0,0] op_sel_hi:[1,0]
    v_pk_mul_f32 v[84:85], v[84:85], v[26:27] op_sel:[0,0] op_sel_hi:[1,0]
    v_pk_mul_f32 v[86:87], v[86:87], v[26:27] op_sel:[0,0] op_sel_hi:[1,0]
    v_cvt_pk_bf16_f32 v80, v80, v81
    v_cvt_pk_bf16_f32 v81, v82, v83
    v_cvt_pk_bf16_f32 v82, v84, v85
    v_cvt_pk_bf16_f32 v83, v86, v87
    s_waitcnt lgkmcnt(0)
    buffer_store_dwordx4 v[132:135], v152, s[20:23], s39 offen offset:256 sc0 sc1
    ds_write_b128 v148, v[80:83] offset:4608
    ds_read_b64_tr_b16 v[136:137], v150 offset:4608
    ds_read_b64_tr_b16 v[138:139], v151 offset:4608
    v_accvgpr_read_b32 v88, a15
    v_accvgpr_read_b32 v89, a31
    v_accvgpr_read_b32 v90, a47
    v_accvgpr_read_b32 v91, a63
    v_accvgpr_read_b32 v92, a79
    v_accvgpr_read_b32 v93, a95
    v_accvgpr_read_b32 v94, a111
    v_accvgpr_read_b32 v95, a127
    v_pk_mul_f32 v[88:89], v[88:89], v[26:27] op_sel:[0,1] op_sel_hi:[1,1]
    v_pk_mul_f32 v[90:91], v[90:91], v[26:27] op_sel:[0,1] op_sel_hi:[1,1]
    v_pk_mul_f32 v[92:93], v[92:93], v[26:27] op_sel:[0,1] op_sel_hi:[1,1]
    v_pk_mul_f32 v[94:95], v[94:95], v[26:27] op_sel:[0,1] op_sel_hi:[1,1]
    v_cvt_pk_bf16_f32 v88, v88, v89
    v_cvt_pk_bf16_f32 v89, v90, v91
    v_cvt_pk_bf16_f32 v90, v92, v93
    v_cvt_pk_bf16_f32 v91, v94, v95
    s_waitcnt lgkmcnt(0)
    buffer_store_dwordx4 v[136:139], v152, s[20:23], s39 offen offset:512 sc0 sc1
    ds_write_b128 v148, v[88:91] offset:4864
    ds_read_b64_tr_b16 v[140:141], v150 offset:4864
    ds_read_b64_tr_b16 v[142:143], v151 offset:4864
    s_waitcnt lgkmcnt(0)
    buffer_store_dwordx4 v[140:143], v152, s[20:23], s39 offen offset:768 sc0 sc1
    v_add_f32 v21, v144, v145
    v_add_f32 v22, v146, v147
    v_add_f32 v21, v21, v22
    s_mov_b32 s31, 0x5b800000
    v_cmp_nge_f32 vcc, s31, v21
    s_cbranch_vccnz L_slow
L_done:
L_end:
    s_endpgm
L_hotend:
L_slow:
    s_waitcnt vmcnt(0) lgkmcnt(0)
    s_barrier
    s_lshl_b32 s30, s28, 14
    buffer_load_dwordx4 v[160:163], v17, s[12:15], s36 offen offset:0 nt
    buffer_load_dwordx4 v[164:167], v17, s[12:15], s36 offen offset:64 nt
    buffer_load_dwordx4 v[168:171], v17, s[12:15], s36 offen offset:128 nt
    buffer_load_dwordx4 v[172:175], v17, s[12:15], s36 offen offset:192 nt
    buffer_load_dwordx4 v[176:179], v17, s[12:15], s37 offen offset:0 nt
    buffer_load_dwordx4 v[180:183], v17, s[12:15], s37 offen offset:64 nt
    buffer_load_dwordx4 v[184:187], v17, s[12:15], s37 offen offset:128 nt
    buffer_load_dwordx4 v[188:191], v17, s[12:15], s37 offen offset:192 nt
    buffer_load_dwordx4 v[192:195], v17, s[12:15], s38 offen offset:0 nt
    buffer_load_dwordx4 v[196:199], v17, s[12:15], s38 offen offset:64 nt
    buffer_load_dwordx4 v[200:203], v17, s[12:15], s38 offen offset:128 nt
    buffer_load_dwordx4 v[204:207], v17, s[12:15], s38 offen offset:192 nt
    buffer_load_dwordx4 v[208:211], v17, s[12:15], s39 offen offset:0 nt
    buffer_load_dwordx4 v[212:215], v17, s[12:15], s39 offen offset:64 nt
    buffer_load_dwordx4 v[216:219], v17, s[12:15], s39 offen offset:128 nt
    buffer_load_dwordx4 v[220:223], v17, s[12:15], s39 offen offset:192 nt
    s_add_u32 s16, s6, s47
    s_addc_u32 s17, s7, 0
    s_add_u32 s56, s8, s47
    s_addc_u32 s57, s9, 0
    s_mov_b32 s58, 0x80000
    s_mov_b32 s59, 0x20000
    v_lshrrev_b32 v20, 4, v0
    v_and_b32 v21, 15, v0
    v_lshlrev_b32 v22, 8, v20
    v_xor_b32 v23, v20, v21
    v_lshl_add_u32 v13, v23, 4, v22
    v_xor_b32 v14, 64, v13
    v_xor_b32 v15, 128, v13
    v_xor_b32 v16, 192, v13
    v_mov_b32 v157, v13
    v_xor_b32 v158, 0x80, v157
    v_add_u32 v1, s30, v1
    v_add_u32 v2, s30, v2
    v_add_u32 v3, s30, v3
    v_add_u32 v4, s30, v4
    s_sub_u32 s31, s30, 0xe000
    v_add_u32 v5, s31, v5
    v_add_u32 v6, s31, v6
    v_add_u32 v7, s31, v7
    v_add_u32 v8, s31, v8
    v_add_u32 v9, s31, v9
    v_add_u32 v10, s31, v10
    v_add_u32 v11, s31, v11
    v_add_u32 v12, s31, v12
    v_accvgpr_write_b32 a0, 0
    v_accvgpr_write_b32 a1, 0
    v_accvgpr_write_b32 a2, 0
    v_accvgpr_write_b32 a3, 0
    v_accvgpr_write_b32 a4, 0
    v_accvgpr_write_b32 a5, 0
    v_accvgpr_write_b32 a6, 0
    v_accvgpr_write_b32 a7, 0
    v_accvgpr_write_b32 a8, 0
    v_accvgpr_write_b32 a9, 0
    v_accvgpr_write_b32 a10, 0
    v_accvgpr_write_b32 a11, 0
    v_accvgpr_write_b32 a12, 0
    v_accvgpr_write_b32 a13, 0
    v_accvgpr_write_b32 a14, 0
    v_accvgpr_write_b32 a15, 0
    v_accvgpr_write_b32 a16, 0
    v_accvgpr_write_b32 a17, 0
    v_accvgpr_write_b32 a18, 0
    v_accvgpr_write_b32 a19, 0
    v_accvgpr_write_b32 a20, 0
    v_accvgpr_write_b32 a21, 0
    v_accvgpr_write_b32 a22, 0
    v_accvgpr_write_b32 a23, 0
    v_accvgpr_write_b32 a24, 0
    v_accvgpr_write_b32 a25, 0
    v_accvgpr_write_b32 a26, 0
    v_accvgpr_write_b32 a27, 0
    v_accvgpr_write_b32 a28, 0
    v_accvgpr_write_b32 a29, 0
    v_accvgpr_write_b32 a30, 0
    v_accvgpr_write_b32 a31, 0
    v_accvgpr_write_b32 a32, 0
    v_accvgpr_write_b32 a33, 0
    v_accvgpr_write_b32 a34, 0
    v_accvgpr_write_b32 a35, 0
    v_accvgpr_write_b32 a36, 0
    v_accvgpr_write_b32 a37, 0
    v_accvgpr_write_b32 a38, 0
    v_accvgpr_write_b32 a39, 0
    v_accvgpr_write_b32 a40, 0
    v_accvgpr_write_b32 a41, 0
    v_accvgpr_write_b32 a42, 0
    v_accvgpr_write_b32 a43, 0
    v_accvgpr_write_b32 a44, 0
    v_accvgpr_write_b32 a45, 0
    v_accvgpr_write_b32 a46, 0
    v_accvgpr_write_b32 a47, 0
    v_accvgpr_write_b32 a48, 0
    v_accvgpr_write_b32 a49, 0
    v_accvgpr_write_b32 a50, 0
    v_accvgpr_write_b32 a51, 0
    v_accvgpr_write_b32 a52, 0
    v_accvgpr_write_b32 a53, 0
    v_accvgpr_write_b32 a54, 0
    v_accvgpr_write_b32 a55, 0
    v_accvgpr_write_b32 a56, 0
    v_accvgpr_write_b32 a57, 0
    v_accvgpr_write_b32 a58, 0
    v_accvgpr_write_b32 a59, 0
    v_accvgpr_write_b32 a60, 0
    v_accvgpr_write_b32 a61, 0
    v_accvgpr_write_b32 a62, 0
    v_accvgpr_write_b32 a63, 0
    v_accvgpr_write_b32 a64, 0
    v_accvgpr_write_b32 a65, 0
    v_accvgpr_write_b32 a66, 0
    v_accvgpr_write_b32 a67, 0
    v_accvgpr_write_b32 a68, 0
    v_accvgpr_write_b32 a69, 0
    v_accvgpr_write_b32 a70, 0
    v_accvgpr_write_b32 a71, 0
    v_accvgpr_write_b32 a72, 0
    v_accvgpr_write_b32 a73, 0
    v_accvgpr_write_b32 a74, 0
    v_accvgpr_write_b32 a75, 0
    v_accvgpr_write_b32 a76, 0
    v_accvgpr_write_b32 a77, 0
    v_accvgpr_write_b32 a78, 0
    v_accvgpr_write_b32 a79, 0
    v_accvgpr_write_b32 a80, 0
    v_accvgpr_write_b32 a81, 0
    v_accvgpr_write_b32 a82, 0
    v_accvgpr_write_b32 a83, 0
    v_accvgpr_write_b32 a84, 0
    v_accvgpr_write_b32 a85, 0
    v_accvgpr_write_b32 a86, 0
    v_accvgpr_write_b32 a87, 0
    v_accvgpr_write_b32 a88, 0
    v_accvgpr_write_b32 a89, 0
    v_accvgpr_write_b32 a90, 0
    v_accvgpr_write_b32 a91, 0
    v_accvgpr_write_b32 a92, 0
    v_accvgpr_write_b32 a93, 0
    v_accvgpr_write_b32 a94, 0
    v_accvgpr_write_b32 a95, 0
    v_accvgpr_write_b32 a96, 0
    v_accvgpr_write_b32 a97, 0
    v_accvgpr_write_b32 a98, 0
    v_accvgpr_write_b32 a99, 0
    v_accvgpr_write_b32 a100, 0
    v_accvgpr_write_b32 a101, 0
    v_accvgpr_write_b32 a102, 0
    v_accvgpr_write_b32 a103, 0
    v_accvgpr_write_b32 a104, 0
    v_accvgpr_write_b32 a105, 0
    v_accvgpr_write_b32 a106, 0
    v_accvgpr_write_b32 a107, 0
    v_accvgpr_write_b32 a108, 0
    v_accvgpr_write_b32 a109, 0
    v_accvgpr_write_b32 a110, 0
    v_accvgpr_write_b32 a111, 0
    v_accvgpr_write_b32 a112, 0
    v_accvgpr_write_b32 a113, 0
    v_accvgpr_write_b32 a114, 0
    v_accvgpr_write_b32 a115, 0
    v_accvgpr_write_b32 a116, 0
    v_accvgpr_write_b32 a117, 0
    v_accvgpr_write_b32 a118, 0
    v_accvgpr_write_b32 a119, 0
    v_accvgpr_write_b32 a120, 0
    v_accvgpr_write_b32 a121, 0
    v_accvgpr_write_b32 a122, 0
    v_accvgpr_write_b32 a123, 0
    v_accvgpr_write_b32 a124, 0
    v_accvgpr_write_b32 a125, 0
    v_accvgpr_write_b32 a126, 0
    v_accvgpr_write_b32 a127, 0
    v_mov_b32 v144, 0
    v_mov_b32 v128, 0xff800000
    v_mov_b32 v145, 0
    v_mov_b32 v129, 0xff800000
    v_mov_b32 v146, 0
    v_mov_b32 v130, 0xff800000
    v_mov_b32 v147, 0
    v_mov_b32 v131, 0xff800000
    s_waitcnt vmcnt(0)
    v_lshlrev_b32 v20, 16, v160
    v_and_b32 v21, s46, v160
    v_lshlrev_b32 v22, 16, v161
    v_and_b32 v23, s46, v161
    v_lshlrev_b32 v24, 16, v162
    v_and_b32 v25, s46, v162
    v_lshlrev_b32 v26, 16, v163
    v_and_b32 v27, s46, v163
    v_pk_mul_f32 v[20:21], v[20:21], s[34:35]
    v_pk_mul_f32 v[22:23], v[22:23], s[34:35]
    v_pk_mul_f32 v[24:25], v[24:25], s[34:35]
    v_pk_mul_f32 v[26:27], v[26:27], s[34:35]
    v_cvt_pk_bf16_f32 v160, v20, v21
    v_cvt_pk_bf16_f32 v161, v22, v23
    v_cvt_pk_bf16_f32 v162, v24, v25
    v_cvt_pk_bf16_f32 v163, v26, v27
    v_lshlrev_b32 v20, 16, v164
    v_and_b32 v21, s46, v164
    v_lshlrev_b32 v22, 16, v165
    v_and_b32 v23, s46, v165
    v_lshlrev_b32 v24, 16, v166
    v_and_b32 v25, s46, v166
    v_lshlrev_b32 v26, 16, v167
    v_and_b32 v27, s46, v167
    v_pk_mul_f32 v[20:21], v[20:21], s[34:35]
    v_pk_mul_f32 v[22:23], v[22:23], s[34:35]
    v_pk_mul_f32 v[24:25], v[24:25], s[34:35]
    v_pk_mul_f32 v[26:27], v[26:27], s[34:35]
    v_cvt_pk_bf16_f32 v164, v20, v21
    v_cvt_pk_bf16_f32 v165, v22, v23
    v_cvt_pk_bf16_f32 v166, v24, v25
    v_cvt_pk_bf16_f32 v167, v26, v27
    v_lshlrev_b32 v20, 16, v168
    v_and_b32 v21, s46, v168
    v_lshlrev_b32 v22, 16, v169
    v_and_b32 v23, s46, v169
    v_lshlrev_b32 v24, 16, v170
    v_and_b32 v25, s46, v170
    v_lshlrev_b32 v26, 16, v171
    v_and_b32 v27, s46, v171
    v_pk_mul_f32 v[20:21], v[20:21], s[34:35]
    v_pk_mul_f32 v[22:23], v[22:23], s[34:35]
    v_pk_mul_f32 v[24:25], v[24:25], s[34:35]
    v_pk_mul_f32 v[26:27], v[26:27], s[34:35]
    v_cvt_pk_bf16_f32 v168, v20, v21
    v_cvt_pk_bf16_f32 v169, v22, v23
    v_cvt_pk_bf16_f32 v170, v24, v25
    v_cvt_pk_bf16_f32 v171, v26, v27
    v_lshlrev_b32 v20, 16, v172
    v_and_b32 v21, s46, v172
    v_lshlrev_b32 v22, 16, v173
    v_and_b32 v23, s46, v173
    v_lshlrev_b32 v24, 16, v174
    v_and_b32 v25, s46, v174
    v_lshlrev_b32 v26, 16, v175
    v_and_b32 v27, s46, v175
    v_pk_mul_f32 v[20:21], v[20:21], s[34:35]
    v_pk_mul_f32 v[22:23], v[22:23], s[34:35]
    v_pk_mul_f32 v[24:25], v[24:25], s[34:35]
    v_pk_mul_f32 v[26:27], v[26:27], s[34:35]
    v_cvt_pk_bf16_f32 v172, v20, v21
    v_cvt_pk_bf16_f32 v173, v22, v23
    v_cvt_pk_bf16_f32 v174, v24, v25
    v_cvt_pk_bf16_f32 v175, v26, v27
    v_lshlrev_b32 v20, 16, v176
    v_and_b32 v21, s46, v176
    v_lshlrev_b32 v22, 16, v177
    v_and_b32 v23, s46, v177
    v_lshlrev_b32 v24, 16, v178
    v_and_b32 v25, s46, v178
    v_lshlrev_b32 v26, 16, v179
    v_and_b32 v27, s46, v179
    v_pk_mul_f32 v[20:21], v[20:21], s[34:35]
    v_pk_mul_f32 v[22:23], v[22:23], s[34:35]
    v_pk_mul_f32 v[24:25], v[24:25], s[34:35]
    v_pk_mul_f32 v[26:27], v[26:27], s[34:35]
    v_cvt_pk_bf16_f32 v176, v20, v21
    v_cvt_pk_bf16_f32 v177, v22, v23
    v_cvt_pk_bf16_f32 v178, v24, v25
    v_cvt_pk_bf16_f32 v179, v26, v27
    v_lshlrev_b32 v20, 16, v180
    v_and_b32 v21, s46, v180
    v_lshlrev_b32 v22, 16, v181
    v_and_b32 v23, s46, v181
    v_lshlrev_b32 v24, 16, v182
    v_and_b32 v25, s46, v182
    v_lshlrev_b32 v26, 16, v183
    v_and_b32 v27, s46, v183
    v_pk_mul_f32 v[20:21], v[20:21], s[34:35]
    v_pk_mul_f32 v[22:23], v[22:23], s[34:35]
    v_pk_mul_f32 v[24:25], v[24:25], s[34:35]
    v_pk_mul_f32 v[26:27], v[26:27], s[34:35]
    v_cvt_pk_bf16_f32 v180, v20, v21
    v_cvt_pk_bf16_f32 v181, v22, v23
    v_cvt_pk_bf16_f32 v182, v24, v25
    v_cvt_pk_bf16_f32 v183, v26, v27
    v_lshlrev_b32 v20, 16, v184
    v_and_b32 v21, s46, v184
    v_lshlrev_b32 v22, 16, v185
    v_and_b32 v23, s46, v185
    v_lshlrev_b32 v24, 16, v186
    v_and_b32 v25, s46, v186
    v_lshlrev_b32 v26, 16, v187
    v_and_b32 v27, s46, v187
    v_pk_mul_f32 v[20:21], v[20:21], s[34:35]
    v_pk_mul_f32 v[22:23], v[22:23], s[34:35]
    v_pk_mul_f32 v[24:25], v[24:25], s[34:35]
    v_pk_mul_f32 v[26:27], v[26:27], s[34:35]
    v_cvt_pk_bf16_f32 v184, v20, v21
    v_cvt_pk_bf16_f32 v185, v22, v23
    v_cvt_pk_bf16_f32 v186, v24, v25
    v_cvt_pk_bf16_f32 v187, v26, v27
    v_lshlrev_b32 v20, 16, v188
    v_and_b32 v21, s46, v188
    v_lshlrev_b32 v22, 16, v189
    v_and_b32 v23, s46, v189
    v_lshlrev_b32 v24, 16, v190
    v_and_b32 v25, s46, v190
    v_lshlrev_b32 v26, 16, v191
    v_and_b32 v27, s46, v191
    v_pk_mul_f32 v[20:21], v[20:21], s[34:35]
    v_pk_mul_f32 v[22:23], v[22:23], s[34:35]
    v_pk_mul_f32 v[24:25], v[24:25], s[34:35]
    v_pk_mul_f32 v[26:27], v[26:27], s[34:35]
    v_cvt_pk_bf16_f32 v188, v20, v21
    v_cvt_pk_bf16_f32 v189, v22, v23
    v_cvt_pk_bf16_f32 v190, v24, v25
    v_cvt_pk_bf16_f32 v191, v26, v27
    v_lshlrev_b32 v20, 16, v192
    v_and_b32 v21, s46, v192
    v_lshlrev_b32 v22, 16, v193
    v_and_b32 v23, s46, v193
    v_lshlrev_b32 v24, 16, v194
    v_and_b32 v25, s46, v194
    v_lshlrev_b32 v26, 16, v195
    v_and_b32 v27, s46, v195
    v_pk_mul_f32 v[20:21], v[20:21], s[34:35]
    v_pk_mul_f32 v[22:23], v[22:23], s[34:35]
    v_pk_mul_f32 v[24:25], v[24:25], s[34:35]
    v_pk_mul_f32 v[26:27], v[26:27], s[34:35]
    v_cvt_pk_bf16_f32 v192, v20, v21
    v_cvt_pk_bf16_f32 v193, v22, v23
    v_cvt_pk_bf16_f32 v194, v24, v25
    v_cvt_pk_bf16_f32 v195, v26, v27
    v_lshlrev_b32 v20, 16, v196
    v_and_b32 v21, s46, v196
    v_lshlrev_b32 v22, 16, v197
    v_and_b32 v23, s46, v197
    v_lshlrev_b32 v24, 16, v198
    v_and_b32 v25, s46, v198
    v_lshlrev_b32 v26, 16, v199
    v_and_b32 v27, s46, v199
    v_pk_mul_f32 v[20:21], v[20:21], s[34:35]
    v_pk_mul_f32 v[22:23], v[22:23], s[34:35]
    v_pk_mul_f32 v[24:25], v[24:25], s[34:35]
    v_pk_mul_f32 v[26:27], v[26:27], s[34:35]
    v_cvt_pk_bf16_f32 v196, v20, v21
    v_cvt_pk_bf16_f32 v197, v22, v23
    v_cvt_pk_bf16_f32 v198, v24, v25
    v_cvt_pk_bf16_f32 v199, v26, v27
    v_lshlrev_b32 v20, 16, v200
    v_and_b32 v21, s46, v200
    v_lshlrev_b32 v22, 16, v201
    v_and_b32 v23, s46, v201
    v_lshlrev_b32 v24, 16, v202
    v_and_b32 v25, s46, v202
    v_lshlrev_b32 v26, 16, v203
    v_and_b32 v27, s46, v203
    v_pk_mul_f32 v[20:21], v[20:21], s[34:35]
    v_pk_mul_f32 v[22:23], v[22:23], s[34:35]
    v_pk_mul_f32 v[24:25], v[24:25], s[34:35]
    v_pk_mul_f32 v[26:27], v[26:27], s[34:35]
    v_cvt_pk_bf16_f32 v200, v20, v21
    v_cvt_pk_bf16_f32 v201, v22, v23
    v_cvt_pk_bf16_f32 v202, v24, v25
    v_cvt_pk_bf16_f32 v203, v26, v27
    v_lshlrev_b32 v20, 16, v204
    v_and_b32 v21, s46, v204
    v_lshlrev_b32 v22, 16, v205
    v_and_b32 v23, s46, v205
    v_lshlrev_b32 v24, 16, v206
    v_and_b32 v25, s46, v206
    v_lshlrev_b32 v26, 16, v207
    v_and_b32 v27, s46, v207
    v_pk_mul_f32 v[20:21], v[20:21], s[34:35]
    v_pk_mul_f32 v[22:23], v[22:23], s[34:35]
    v_pk_mul_f32 v[24:25], v[24:25], s[34:35]
    v_pk_mul_f32 v[26:27], v[26:27], s[34:35]
    v_cvt_pk_bf16_f32 v204, v20, v21
    v_cvt_pk_bf16_f32 v205, v22, v23
    v_cvt_pk_bf16_f32 v206, v24, v25
    v_cvt_pk_bf16_f32 v207, v26, v27
    v_lshlrev_b32 v20, 16, v208
    v_and_b32 v21, s46, v208
    v_lshlrev_b32 v22, 16, v209
    v_and_b32 v23, s46, v209
    v_lshlrev_b32 v24, 16, v210
    v_and_b32 v25, s46, v210
    v_lshlrev_b32 v26, 16, v211
    v_and_b32 v27, s46, v211
    v_pk_mul_f32 v[20:21], v[20:21], s[34:35]
    v_pk_mul_f32 v[22:23], v[22:23], s[34:35]
    v_pk_mul_f32 v[24:25], v[24:25], s[34:35]
    v_pk_mul_f32 v[26:27], v[26:27], s[34:35]
    v_cvt_pk_bf16_f32 v208, v20, v21
    v_cvt_pk_bf16_f32 v209, v22, v23
    v_cvt_pk_bf16_f32 v210, v24, v25
    v_cvt_pk_bf16_f32 v211, v26, v27
    v_lshlrev_b32 v20, 16, v212
    v_and_b32 v21, s46, v212
    v_lshlrev_b32 v22, 16, v213
    v_and_b32 v23, s46, v213
    v_lshlrev_b32 v24, 16, v214
    v_and_b32 v25, s46, v214
    v_lshlrev_b32 v26, 16, v215
    v_and_b32 v27, s46, v215
    v_pk_mul_f32 v[20:21], v[20:21], s[34:35]
    v_pk_mul_f32 v[22:23], v[22:23], s[34:35]
    v_pk_mul_f32 v[24:25], v[24:25], s[34:35]
    v_pk_mul_f32 v[26:27], v[26:27], s[34:35]
    v_cvt_pk_bf16_f32 v212, v20, v21
    v_cvt_pk_bf16_f32 v213, v22, v23
    v_cvt_pk_bf16_f32 v214, v24, v25
    v_cvt_pk_bf16_f32 v215, v26, v27
    v_lshlrev_b32 v20, 16, v216
    v_and_b32 v21, s46, v216
    v_lshlrev_b32 v22, 16, v217
    v_and_b32 v23, s46, v217
    v_lshlrev_b32 v24, 16, v218
    v_and_b32 v25, s46, v218
    v_lshlrev_b32 v26, 16, v219
    v_and_b32 v27, s46, v219
    v_pk_mul_f32 v[20:21], v[20:21], s[34:35]
    v_pk_mul_f32 v[22:23], v[22:23], s[34:35]
    v_pk_mul_f32 v[24:25], v[24:25], s[34:35]
    v_pk_mul_f32 v[26:27], v[26:27], s[34:35]
    v_cvt_pk_bf16_f32 v216, v20, v21
    v_cvt_pk_bf16_f32 v217, v22, v23
    v_cvt_pk_bf16_f32 v218, v24, v25
    v_cvt_pk_bf16_f32 v219, v26, v27
    v_lshlrev_b32 v20, 16, v220
    v_and_b32 v21, s46, v220
    v_lshlrev_b32 v22, 16, v221
    v_and_b32 v23, s46, v221
    v_lshlrev_b32 v24, 16, v222
    v_and_b32 v25, s46, v222
    v_lshlrev_b32 v26, 16, v223
    v_and_b32 v27, s46, v223
    v_pk_mul_f32 v[20:21], v[20:21], s[34:35]
    v_pk_mul_f32 v[22:23], v[22:23], s[34:35]
    v_pk_mul_f32 v[24:25], v[24:25], s[34:35]
    v_pk_mul_f32 v[26:27], v[26:27], s[34:35]
    v_cvt_pk_bf16_f32 v220, v20, v21
    v_cvt_pk_bf16_f32 v221, v22, v23
    v_cvt_pk_bf16_f32 v222, v24, v25
    v_cvt_pk_bf16_f32 v223, v26, v27
    s_mov_b32 s29, 0
L_sloop:
    s_add_u32 m0, s30, 0
    s_add_u32 s42, s29, 0
    buffer_load_dwordx4 v13, s[16:19], s42 offen offset:0 lds
    buffer_load_dwordx4 v14, s[16:19], s42 offen offset:1024 lds
    buffer_load_dwordx4 v15, s[16:19], s42 offen offset:2048 lds
    buffer_load_dwordx4 v16, s[16:19], s42 offen offset:3072 lds
    s_add_u32 m0, s30, 8192
    s_nop 0
    buffer_load_dwordx4 v157, s[56:59], s42 offen offset:0 lds
    buffer_load_dwordx4 v158, s[56:59], s42 offen offset:1024 lds
    buffer_load_dwordx4 v157, s[56:59], s42 offen offset:2048 lds
    buffer_load_dwordx4 v158, s[56:59], s42 offen offset:3072 lds
    s_add_u32 m0, s30, 4096
    s_add_u32 s42, s29, 4096
    buffer_load_dwordx4 v13, s[16:19], s42 offen offset:0 lds
    buffer_load_dwordx4 v14, s[16:19], s42 offen offset:1024 lds
    buffer_load_dwordx4 v15, s[16:19], s42 offen offset:2048 lds
    buffer_load_dwordx4 v16, s[16:19], s42 offen offset:3072 lds
    s_add_u32 m0, s30, 12288
    s_nop 0
    buffer_load_dwordx4 v157, s[56:59], s42 offen offset:0 lds
    buffer_load_dwordx4 v158, s[56:59], s42 offen offset:1024 lds
    buffer_load_dwordx4 v157, s[56:59], s42 offen offset:2048 lds
    buffer_load_dwordx4 v158, s[56:59], s42 offen offset:3072 lds
    s_waitcnt vmcnt(0)
    ds_read_b128 a[128:131], v1 offset:0
    ds_read_b128 a[132:135], v2 offset:0
    ds_read_b128 a[136:139], v3 offset:0
    ds_read_b128 a[140:143], v4 offset:0
    s_waitcnt lgkmcnt(0)
    v_mfma_f32_16x16x32_bf16 v[32:35], a[128:131], v[160:163], 0
    v_mfma_f32_16x16x32_bf16 v[32:35], a[132:135], v[164:167], v[32:35]
    v_mfma_f32_16x16x32_bf16 v[32:35], a[136:139], v[168:171], v[32:35]
    v_mfma_f32_16x16x32_bf16 v[32:35], a[140:143], v[172:175], v[32:35]
    v_mfma_f32_16x16x32_bf16 v[36:39], a[140:143], v[188:191], 0
    v_mfma_f32_16x16x32_bf16 v[36:39], a[136:139], v[184:187], v[36:39]
    v_mfma_f32_16x16x32_bf16 v[36:39], a[132:135], v[180:183], v[36:39]
    v_mfma_f32_16x16x32_bf16 v[36:39], a[128:131], v[176:179], v[36:39]
    v_mfma_f32_16x16x32_bf16 v[40:43], a[128:131], v[192:195], 0
    v_mfma_f32_16x16x32_bf16 v[40:43], a[132:135], v[196:199], v[40:43]
    v_mfma_f32_16x16x32_bf16 v[40:43], a[136:139], v[200:203], v[40:43]
    v_mfma_f32_16x16x32_bf16 v[40:43], a[140:143], v[204:207], v[40:43]
    v_mfma_f32_16x16x32_bf16 v[44:47], a[140:143], v[220:223], 0
    v_mfma_f32_16x16x32_bf16 v[44:47], a[136:139], v[216:219], v[44:47]
    v_mfma_f32_16x16x32_bf16 v[44:47], a[132:135], v[212:215], v[44:47]
    v_mfma_f32_16x16x32_bf16 v[44:47], a[128:131], v[208:211], v[44:47]
    ds_read_b128 a[128:131], v1 offset:4096
    ds_read_b128 a[132:135], v2 offset:4096
    ds_read_b128 a[136:139], v3 offset:4096
    ds_read_b128 a[140:143], v4 offset:4096
    s_waitcnt lgkmcnt(0)
    v_mfma_f32_16x16x32_bf16 v[48:51], a[128:131], v[160:163], 0
    v_mfma_f32_16x16x32_bf16 v[48:51], a[132:135], v[164:167], v[48:51]
    v_mfma_f32_16x16x32_bf16 v[48:51], a[136:139], v[168:171], v[48:51]
    v_mfma_f32_16x16x32_bf16 v[48:51], a[140:143], v[172:175], v[48:51]
    v_mfma_f32_16x16x32_bf16 v[52:55], a[140:143], v[188:191], 0
    v_mfma_f32_16x16x32_bf16 v[52:55], a[136:139], v[184:187], v[52:55]
    v_mfma_f32_16x16x32_bf16 v[52:55], a[132:135], v[180:183], v[52:55]
    v_mfma_f32_16x16x32_bf16 v[52:55], a[128:131], v[176:179], v[52:55]
    v_mfma_f32_16x16x32_bf16 v[56:59], a[128:131], v[192:195], 0
    v_mfma_f32_16x16x32_bf16 v[56:59], a[132:135], v[196:199], v[56:59]
    v_mfma_f32_16x16x32_bf16 v[56:59], a[136:139], v[200:203], v[56:59]
    v_mfma_f32_16x16x32_bf16 v[56:59], a[140:143], v[204:207], v[56:59]
    v_mfma_f32_16x16x32_bf16 v[60:63], a[140:143], v[220:223], 0
    v_mfma_f32_16x16x32_bf16 v[60:63], a[136:139], v[216:219], v[60:63]
    v_mfma_f32_16x16x32_bf16 v[60:63], a[132:135], v[212:215], v[60:63]
    v_mfma_f32_16x16x32_bf16 v[60:63], a[128:131], v[208:211], v[60:63]
    v_max3_f32 v136, v32, v33, v34
    v_max3_f32 v136, v136, v35, v48
    v_max3_f32 v136, v136, v49, v50
    v_max3_f32 v136, v136, v51, v128
    v_max3_f32 v137, v36, v37, v38
    v_max3_f32 v137, v137, v39, v52
    v_max3_f32 v137, v137, v53, v54
    v_max3_f32 v137, v137, v55, v129
    v_max3_f32 v138, v40, v41, v42
    v_max3_f32 v138, v138, v43, v56
    v_max3_f32 v138, v138, v57, v58
    v_max3_f32 v138, v138, v59, v130
    v_max3_f32 v139, v44, v45, v46
    v_max3_f32 v139, v139, v47, v60
    v_max3_f32 v139, v139, v61, v62
    v_max3_f32 v139, v139, v63, v131
    v_mov_b32 v140, v136
    v_mov_b32 v141, v137
    v_mov_b32 v142, v138
    v_mov_b32 v143, v139
    v_permlane32_swap_b32 v136, v140
    v_permlane32_swap_b32 v137, v141
    v_permlane32_swap_b32 v138, v142
    v_permlane32_swap_b32 v139, v143
    v_max_f32 v136, v136, v140
    v_max_f32 v137, v137, v141
    v_max_f32 v138, v138, v142
    v_max_f32 v139, v139, v143
    v_mov_b32 v140, v136
    v_mov_b32 v141, v137
    v_mov_b32 v142, v138
    v_mov_b32 v143, v139
    v_permlane16_swap_b32 v136, v140
    v_permlane16_swap_b32 v137, v141
    v_permlane16_swap_b32 v138, v142
    v_permlane16_swap_b32 v139, v143
    v_max_f32 v136, v136, v140
    v_max_f32 v137, v137, v141
    v_max_f32 v138, v138, v142
    v_max_f32 v139, v139, v143
    v_sub_f32 v132, v128, v136
    v_sub_f32 v133, v129, v137
    v_sub_f32 v134, v130, v138
    v_sub_f32 v135, v131, v139
    v_exp_f32 v132, v132
    v_exp_f32 v133, v133
    v_exp_f32 v134, v134
    v_exp_f32 v135, v135
    v_mov_b32 v128, v136
    v_mov_b32 v129, v137
    v_mov_b32 v130, v138
    v_mov_b32 v131, v139
    v_sub_f32 v32, v32, v136
    v_sub_f32 v33, v33, v136
    v_sub_f32 v34, v34, v136
    v_sub_f32 v35, v35, v136
    v_exp_f32 v32, v32
    v_exp_f32 v33, v33
    v_exp_f32 v34, v34
    v_exp_f32 v35, v35
    v_sub_f32 v36, v36, v137
    v_sub_f32 v37, v37, v137
    v_sub_f32 v38, v38, v137
    v_sub_f32 v39, v39, v137
    v_exp_f32 v36, v36
    v_exp_f32 v37, v37
    v_exp_f32 v38, v38
    v_exp_f32 v39, v39
    v_sub_f32 v40, v40, v138
    v_sub_f32 v41, v41, v138
    v_sub_f32 v42, v42, v138
    v_sub_f32 v43, v43, v138
    v_exp_f32 v40, v40
    v_exp_f32 v41, v41
    v_exp_f32 v42, v42
    v_exp_f32 v43, v43
    v_sub_f32 v44, v44, v139
    v_sub_f32 v45, v45, v139
    v_sub_f32 v46, v46, v139
    v_sub_f32 v47, v47, v139
    v_exp_f32 v44, v44
    v_exp_f32 v45, v45
    v_exp_f32 v46, v46
    v_exp_f32 v47, v47
    v_sub_f32 v48, v48, v136
    v_sub_f32 v49, v49, v136
    v_sub_f32 v50, v50, v136
    v_sub_f32 v51, v51, v136
    v_exp_f32 v48, v48
    v_exp_f32 v49, v49
    v_exp_f32 v50, v50
    v_exp_f32 v51, v51
    v_sub_f32 v52, v52, v137
    v_sub_f32 v53, v53, v137
    v_sub_f32 v54, v54, v137
    v_sub_f32 v55, v55, v137
    v_exp_f32 v52, v52
    v_exp_f32 v53, v53
    v_exp_f32 v54, v54
    v_exp_f32 v55, v55
    v_sub_f32 v56, v56, v138
    v_sub_f32 v57, v57, v138
    v_sub_f32 v58, v58, v138
    v_sub_f32 v59, v59, v138
    v_exp_f32 v56, v56
    v_exp_f32 v57, v57
    v_exp_f32 v58, v58
    v_exp_f32 v59, v59
    v_sub_f32 v60, v60, v139
    v_sub_f32 v61, v61, v139
    v_sub_f32 v62, v62, v139
    v_sub_f32 v63, v63, v139
    v_exp_f32 v60, v60
    v_exp_f32 v61, v61
    v_exp_f32 v62, v62
    v_exp_f32 v63, v63
    v_cvt_pk_bf16_f32 v64, v32, v33
    v_cvt_pk_bf16_f32 v65, v34, v35
    v_cvt_pk_bf16_f32 v72, v36, v37
    v_cvt_pk_bf16_f32 v73, v38, v39
    v_cvt_pk_bf16_f32 v80, v40, v41
    v_cvt_pk_bf16_f32 v81, v42, v43
    v_cvt_pk_bf16_f32 v88, v44, v45
    v_cvt_pk_bf16_f32 v89, v46, v47
    v_cvt_pk_bf16_f32 v66, v48, v49
    v_cvt_pk_bf16_f32 v67, v50, v51
    v_cvt_pk_bf16_f32 v74, v52, v53
    v_cvt_pk_bf16_f32 v75, v54, v55
    v_cvt_pk_bf16_f32 v82, v56, v57
    v_cvt_pk_bf16_f32 v83, v58, v59
    v_cvt_pk_bf16_f32 v90, v60, v61
    v_cvt_pk_bf16_f32 v91, v62, v63
    v_mul_f32 v144, v144, v132
    v_mul_f32 v145, v145, v133
    v_mul_f32 v146, v146, v134
    v_mul_f32 v147, v147, v135
    v_accvgpr_read_b32 v20, a0
    v_accvgpr_read_b32 v21, a1
    v_accvgpr_read_b32 v22, a2
    v_accvgpr_read_b32 v23, a3
    v_mul_f32 v20, v20, v132
    v_mul_f32 v21, v21, v132
    v_mul_f32 v22, v22, v132
    v_mul_f32 v23, v23, v132
    v_accvgpr_write_b32 a0, v20
    v_accvgpr_write_b32 a1, v21
    v_accvgpr_write_b32 a2, v22
    v_accvgpr_write_b32 a3, v23
    v_accvgpr_read_b32 v20, a4
    v_accvgpr_read_b32 v21, a5
    v_accvgpr_read_b32 v22, a6
    v_accvgpr_read_b32 v23, a7
    v_mul_f32 v20, v20, v133
    v_mul_f32 v21, v21, v133
    v_mul_f32 v22, v22, v133
    v_mul_f32 v23, v23, v133
    v_accvgpr_write_b32 a4, v20
    v_accvgpr_write_b32 a5, v21
    v_accvgpr_write_b32 a6, v22
    v_accvgpr_write_b32 a7, v23
    v_accvgpr_read_b32 v20, a8
    v_accvgpr_read_b32 v21, a9
    v_accvgpr_read_b32 v22, a10
    v_accvgpr_read_b32 v23, a11
    v_mul_f32 v20, v20, v134
    v_mul_f32 v21, v21, v134
    v_mul_f32 v22, v22, v134
    v_mul_f32 v23, v23, v134
    v_accvgpr_write_b32 a8, v20
    v_accvgpr_write_b32 a9, v21
    v_accvgpr_write_b32 a10, v22
    v_accvgpr_write_b32 a11, v23
    v_accvgpr_read_b32 v20, a12
    v_accvgpr_read_b32 v21, a13
    v_accvgpr_read_b32 v22, a14
    v_accvgpr_read_b32 v23, a15
    v_mul_f32 v20, v20, v135
    v_mul_f32 v21, v21, v135
    v_mul_f32 v22, v22, v135
    v_mul_f32 v23, v23, v135
    v_accvgpr_write_b32 a12, v20
    v_accvgpr_write_b32 a13, v21
    v_accvgpr_write_b32 a14, v22
    v_accvgpr_write_b32 a15, v23
    v_accvgpr_read_b32 v20, a16
    v_accvgpr_read_b32 v21, a17
    v_accvgpr_read_b32 v22, a18
    v_accvgpr_read_b32 v23, a19
    v_mul_f32 v20, v20, v132
    v_mul_f32 v21, v21, v132
    v_mul_f32 v22, v22, v132
    v_mul_f32 v23, v23, v132
    v_accvgpr_write_b32 a16, v20
    v_accvgpr_write_b32 a17, v21
    v_accvgpr_write_b32 a18, v22
    v_accvgpr_write_b32 a19, v23
    v_accvgpr_read_b32 v20, a20
    v_accvgpr_read_b32 v21, a21
    v_accvgpr_read_b32 v22, a22
    v_accvgpr_read_b32 v23, a23
    v_mul_f32 v20, v20, v133
    v_mul_f32 v21, v21, v133
    v_mul_f32 v22, v22, v133
    v_mul_f32 v23, v23, v133
    v_accvgpr_write_b32 a20, v20
    v_accvgpr_write_b32 a21, v21
    v_accvgpr_write_b32 a22, v22
    v_accvgpr_write_b32 a23, v23
    v_accvgpr_read_b32 v20, a24
    v_accvgpr_read_b32 v21, a25
    v_accvgpr_read_b32 v22, a26
    v_accvgpr_read_b32 v23, a27
    v_mul_f32 v20, v20, v134
    v_mul_f32 v21, v21, v134
    v_mul_f32 v22, v22, v134
    v_mul_f32 v23, v23, v134
    v_accvgpr_write_b32 a24, v20
    v_accvgpr_write_b32 a25, v21
    v_accvgpr_write_b32 a26, v22
    v_accvgpr_write_b32 a27, v23
    v_accvgpr_read_b32 v20, a28
    v_accvgpr_read_b32 v21, a29
    v_accvgpr_read_b32 v22, a30
    v_accvgpr_read_b32 v23, a31
    v_mul_f32 v20, v20, v135
    v_mul_f32 v21, v21, v135
    v_mul_f32 v22, v22, v135
    v_mul_f32 v23, v23, v135
    v_accvgpr_write_b32 a28, v20
    v_accvgpr_write_b32 a29, v21
    v_accvgpr_write_b32 a30, v22
    v_accvgpr_write_b32 a31, v23
    v_accvgpr_read_b32 v20, a32
    v_accvgpr_read_b32 v21, a33
    v_accvgpr_read_b32 v22, a34
    v_accvgpr_read_b32 v23, a35
    v_mul_f32 v20, v20, v132
    v_mul_f32 v21, v21, v132
    v_mul_f32 v22, v22, v132
    v_mul_f32 v23, v23, v132
    v_accvgpr_write_b32 a32, v20
    v_accvgpr_write_b32 a33, v21
    v_accvgpr_write_b32 a34, v22
    v_accvgpr_write_b32 a35, v23
    v_accvgpr_read_b32 v20, a36
    v_accvgpr_read_b32 v21, a37
    v_accvgpr_read_b32 v22, a38
    v_accvgpr_read_b32 v23, a39
    v_mul_f32 v20, v20, v133
    v_mul_f32 v21, v21, v133
    v_mul_f32 v22, v22, v133
    v_mul_f32 v23, v23, v133
    v_accvgpr_write_b32 a36, v20
    v_accvgpr_write_b32 a37, v21
    v_accvgpr_write_b32 a38, v22
    v_accvgpr_write_b32 a39, v23
    v_accvgpr_read_b32 v20, a40
    v_accvgpr_read_b32 v21, a41
    v_accvgpr_read_b32 v22, a42
    v_accvgpr_read_b32 v23, a43
    v_mul_f32 v20, v20, v134
    v_mul_f32 v21, v21, v134
    v_mul_f32 v22, v22, v134
    v_mul_f32 v23, v23, v134
    v_accvgpr_write_b32 a40, v20
    v_accvgpr_write_b32 a41, v21
    v_accvgpr_write_b32 a42, v22
    v_accvgpr_write_b32 a43, v23
    v_accvgpr_read_b32 v20, a44
    v_accvgpr_read_b32 v21, a45
    v_accvgpr_read_b32 v22, a46
    v_accvgpr_read_b32 v23, a47
    v_mul_f32 v20, v20, v135
    v_mul_f32 v21, v21, v135
    v_mul_f32 v22, v22, v135
    v_mul_f32 v23, v23, v135
    v_accvgpr_write_b32 a44, v20
    v_accvgpr_write_b32 a45, v21
    v_accvgpr_write_b32 a46, v22
    v_accvgpr_write_b32 a47, v23
    v_accvgpr_read_b32 v20, a48
    v_accvgpr_read_b32 v21, a49
    v_accvgpr_read_b32 v22, a50
    v_accvgpr_read_b32 v23, a51
    v_mul_f32 v20, v20, v132
    v_mul_f32 v21, v21, v132
    v_mul_f32 v22, v22, v132
    v_mul_f32 v23, v23, v132
    v_accvgpr_write_b32 a48, v20
    v_accvgpr_write_b32 a49, v21
    v_accvgpr_write_b32 a50, v22
    v_accvgpr_write_b32 a51, v23
    v_accvgpr_read_b32 v20, a52
    v_accvgpr_read_b32 v21, a53
    v_accvgpr_read_b32 v22, a54
    v_accvgpr_read_b32 v23, a55
    v_mul_f32 v20, v20, v133
    v_mul_f32 v21, v21, v133
    v_mul_f32 v22, v22, v133
    v_mul_f32 v23, v23, v133
    v_accvgpr_write_b32 a52, v20
    v_accvgpr_write_b32 a53, v21
    v_accvgpr_write_b32 a54, v22
    v_accvgpr_write_b32 a55, v23
    v_accvgpr_read_b32 v20, a56
    v_accvgpr_read_b32 v21, a57
    v_accvgpr_read_b32 v22, a58
    v_accvgpr_read_b32 v23, a59
    v_mul_f32 v20, v20, v134
    v_mul_f32 v21, v21, v134
    v_mul_f32 v22, v22, v134
    v_mul_f32 v23, v23, v134
    v_accvgpr_write_b32 a56, v20
    v_accvgpr_write_b32 a57, v21
    v_accvgpr_write_b32 a58, v22
    v_accvgpr_write_b32 a59, v23
    v_accvgpr_read_b32 v20, a60
    v_accvgpr_read_b32 v21, a61
    v_accvgpr_read_b32 v22, a62
    v_accvgpr_read_b32 v23, a63
    v_mul_f32 v20, v20, v135
    v_mul_f32 v21, v21, v135
    v_mul_f32 v22, v22, v135
    v_mul_f32 v23, v23, v135
    v_accvgpr_write_b32 a60, v20
    v_accvgpr_write_b32 a61, v21
    v_accvgpr_write_b32 a62, v22
    v_accvgpr_write_b32 a63, v23
    v_accvgpr_read_b32 v20, a64
    v_accvgpr_read_b32 v21, a65
    v_accvgpr_read_b32 v22, a66
    v_accvgpr_read_b32 v23, a67
    v_mul_f32 v20, v20, v132
    v_mul_f32 v21, v21, v132
    v_mul_f32 v22, v22, v132
    v_mul_f32 v23, v23, v132
    v_accvgpr_write_b32 a64, v20
    v_accvgpr_write_b32 a65, v21
    v_accvgpr_write_b32 a66, v22
    v_accvgpr_write_b32 a67, v23
    v_accvgpr_read_b32 v20, a68
    v_accvgpr_read_b32 v21, a69
    v_accvgpr_read_b32 v22, a70
    v_accvgpr_read_b32 v23, a71
    v_mul_f32 v20, v20, v133
    v_mul_f32 v21, v21, v133
    v_mul_f32 v22, v22, v133
    v_mul_f32 v23, v23, v133
    v_accvgpr_write_b32 a68, v20
    v_accvgpr_write_b32 a69, v21
    v_accvgpr_write_b32 a70, v22
    v_accvgpr_write_b32 a71, v23
    v_accvgpr_read_b32 v20, a72
    v_accvgpr_read_b32 v21, a73
    v_accvgpr_read_b32 v22, a74
    v_accvgpr_read_b32 v23, a75
    v_mul_f32 v20, v20, v134
    v_mul_f32 v21, v21, v134
    v_mul_f32 v22, v22, v134
    v_mul_f32 v23, v23, v134
    v_accvgpr_write_b32 a72, v20
    v_accvgpr_write_b32 a73, v21
    v_accvgpr_write_b32 a74, v22
    v_accvgpr_write_b32 a75, v23
    v_accvgpr_read_b32 v20, a76
    v_accvgpr_read_b32 v21, a77
    v_accvgpr_read_b32 v22, a78
    v_accvgpr_read_b32 v23, a79
    v_mul_f32 v20, v20, v135
    v_mul_f32 v21, v21, v135
    v_mul_f32 v22, v22, v135
    v_mul_f32 v23, v23, v135
    v_accvgpr_write_b32 a76, v20
    v_accvgpr_write_b32 a77, v21
    v_accvgpr_write_b32 a78, v22
    v_accvgpr_write_b32 a79, v23
    v_accvgpr_read_b32 v20, a80
    v_accvgpr_read_b32 v21, a81
    v_accvgpr_read_b32 v22, a82
    v_accvgpr_read_b32 v23, a83
    v_mul_f32 v20, v20, v132
    v_mul_f32 v21, v21, v132
    v_mul_f32 v22, v22, v132
    v_mul_f32 v23, v23, v132
    v_accvgpr_write_b32 a80, v20
    v_accvgpr_write_b32 a81, v21
    v_accvgpr_write_b32 a82, v22
    v_accvgpr_write_b32 a83, v23
    v_accvgpr_read_b32 v20, a84
    v_accvgpr_read_b32 v21, a85
    v_accvgpr_read_b32 v22, a86
    v_accvgpr_read_b32 v23, a87
    v_mul_f32 v20, v20, v133
    v_mul_f32 v21, v21, v133
    v_mul_f32 v22, v22, v133
    v_mul_f32 v23, v23, v133
    v_accvgpr_write_b32 a84, v20
    v_accvgpr_write_b32 a85, v21
    v_accvgpr_write_b32 a86, v22
    v_accvgpr_write_b32 a87, v23
    v_accvgpr_read_b32 v20, a88
    v_accvgpr_read_b32 v21, a89
    v_accvgpr_read_b32 v22, a90
    v_accvgpr_read_b32 v23, a91
    v_mul_f32 v20, v20, v134
    v_mul_f32 v21, v21, v134
    v_mul_f32 v22, v22, v134
    v_mul_f32 v23, v23, v134
    v_accvgpr_write_b32 a88, v20
    v_accvgpr_write_b32 a89, v21
    v_accvgpr_write_b32 a90, v22
    v_accvgpr_write_b32 a91, v23
    v_accvgpr_read_b32 v20, a92
    v_accvgpr_read_b32 v21, a93
    v_accvgpr_read_b32 v22, a94
    v_accvgpr_read_b32 v23, a95
    v_mul_f32 v20, v20, v135
    v_mul_f32 v21, v21, v135
    v_mul_f32 v22, v22, v135
    v_mul_f32 v23, v23, v135
    v_accvgpr_write_b32 a92, v20
    v_accvgpr_write_b32 a93, v21
    v_accvgpr_write_b32 a94, v22
    v_accvgpr_write_b32 a95, v23
    v_accvgpr_read_b32 v20, a96
    v_accvgpr_read_b32 v21, a97
    v_accvgpr_read_b32 v22, a98
    v_accvgpr_read_b32 v23, a99
    v_mul_f32 v20, v20, v132
    v_mul_f32 v21, v21, v132
    v_mul_f32 v22, v22, v132
    v_mul_f32 v23, v23, v132
    v_accvgpr_write_b32 a96, v20
    v_accvgpr_write_b32 a97, v21
    v_accvgpr_write_b32 a98, v22
    v_accvgpr_write_b32 a99, v23
    v_accvgpr_read_b32 v20, a100
    v_accvgpr_read_b32 v21, a101
    v_accvgpr_read_b32 v22, a102
    v_accvgpr_read_b32 v23, a103
    v_mul_f32 v20, v20, v133
    v_mul_f32 v21, v21, v133
    v_mul_f32 v22, v22, v133
    v_mul_f32 v23, v23, v133
    v_accvgpr_write_b32 a100, v20
    v_accvgpr_write_b32 a101, v21
    v_accvgpr_write_b32 a102, v22
    v_accvgpr_write_b32 a103, v23
    v_accvgpr_read_b32 v20, a104
    v_accvgpr_read_b32 v21, a105
    v_accvgpr_read_b32 v22, a106
    v_accvgpr_read_b32 v23, a107
    v_mul_f32 v20, v20, v134
    v_mul_f32 v21, v21, v134
    v_mul_f32 v22, v22, v134
    v_mul_f32 v23, v23, v134
    v_accvgpr_write_b32 a104, v20
    v_accvgpr_write_b32 a105, v21
    v_accvgpr_write_b32 a106, v22
    v_accvgpr_write_b32 a107, v23
    v_accvgpr_read_b32 v20, a108
    v_accvgpr_read_b32 v21, a109
    v_accvgpr_read_b32 v22, a110
    v_accvgpr_read_b32 v23, a111
    v_mul_f32 v20, v20, v135
    v_mul_f32 v21, v21, v135
    v_mul_f32 v22, v22, v135
    v_mul_f32 v23, v23, v135
    v_accvgpr_write_b32 a108, v20
    v_accvgpr_write_b32 a109, v21
    v_accvgpr_write_b32 a110, v22
    v_accvgpr_write_b32 a111, v23
    v_accvgpr_read_b32 v20, a112
    v_accvgpr_read_b32 v21, a113
    v_accvgpr_read_b32 v22, a114
    v_accvgpr_read_b32 v23, a115
    v_mul_f32 v20, v20, v132
    v_mul_f32 v21, v21, v132
    v_mul_f32 v22, v22, v132
    v_mul_f32 v23, v23, v132
    v_accvgpr_write_b32 a112, v20
    v_accvgpr_write_b32 a113, v21
    v_accvgpr_write_b32 a114, v22
    v_accvgpr_write_b32 a115, v23
    v_accvgpr_read_b32 v20, a116
    v_accvgpr_read_b32 v21, a117
    v_accvgpr_read_b32 v22, a118
    v_accvgpr_read_b32 v23, a119
    v_mul_f32 v20, v20, v133
    v_mul_f32 v21, v21, v133
    v_mul_f32 v22, v22, v133
    v_mul_f32 v23, v23, v133
    v_accvgpr_write_b32 a116, v20
    v_accvgpr_write_b32 a117, v21
    v_accvgpr_write_b32 a118, v22
    v_accvgpr_write_b32 a119, v23
    v_accvgpr_read_b32 v20, a120
    v_accvgpr_read_b32 v21, a121
    v_accvgpr_read_b32 v22, a122
    v_accvgpr_read_b32 v23, a123
    v_mul_f32 v20, v20, v134
    v_mul_f32 v21, v21, v134
    v_mul_f32 v22, v22, v134
    v_mul_f32 v23, v23, v134
    v_accvgpr_write_b32 a120, v20
    v_accvgpr_write_b32 a121, v21
    v_accvgpr_write_b32 a122, v22
    v_accvgpr_write_b32 a123, v23
    v_accvgpr_read_b32 v20, a124
    v_accvgpr_read_b32 v21, a125
    v_accvgpr_read_b32 v22, a126
    v_accvgpr_read_b32 v23, a127
    v_mul_f32 v20, v20, v135
    v_mul_f32 v21, v21, v135
    v_mul_f32 v22, v22, v135
    v_mul_f32 v23, v23, v135
    v_accvgpr_write_b32 a124, v20
    v_accvgpr_write_b32 a125, v21
    v_accvgpr_write_b32 a126, v22
    v_accvgpr_write_b32 a127, v23
    v_mfma_f32_16x16x32_bf16 v[144:147], a[160:163], v[64:67], v[144:147]
    v_mfma_f32_16x16x32_bf16 v[144:147], a[164:167], v[72:75], v[144:147]
    v_mfma_f32_16x16x32_bf16 v[144:147], a[168:171], v[80:83], v[144:147]
    v_mfma_f32_16x16x32_bf16 v[144:147], a[172:175], v[88:91], v[144:147]
    ds_read_b64_tr_b16 a[144:145], v5 offset:0
    ds_read_b64_tr_b16 a[146:147], v5 offset:4096
    s_waitcnt lgkmcnt(0)
    v_mfma_f32_16x16x32_bf16 a[0:3], a[144:147], v[64:67], a[0:3]
    v_mfma_f32_16x16x32_bf16 a[4:7], a[144:147], v[72:75], a[4:7]
    v_mfma_f32_16x16x32_bf16 a[8:11], a[144:147], v[80:83], a[8:11]
    v_mfma_f32_16x16x32_bf16 a[12:15], a[144:147], v[88:91], a[12:15]
    ds_read_b64_tr_b16 a[152:153], v6 offset:0
    ds_read_b64_tr_b16 a[154:155], v6 offset:4096
    s_waitcnt lgkmcnt(0)
    v_mfma_f32_16x16x32_bf16 a[16:19], a[152:155], v[64:67], a[16:19]
    v_mfma_f32_16x16x32_bf16 a[20:23], a[152:155], v[72:75], a[20:23]
    v_mfma_f32_16x16x32_bf16 a[24:27], a[152:155], v[80:83], a[24:27]
    v_mfma_f32_16x16x32_bf16 a[28:31], a[152:155], v[88:91], a[28:31]
    ds_read_b64_tr_b16 a[144:145], v7 offset:0
    ds_read_b64_tr_b16 a[146:147], v7 offset:4096
    s_waitcnt lgkmcnt(0)
    v_mfma_f32_16x16x32_bf16 a[32:35], a[144:147], v[64:67], a[32:35]
    v_mfma_f32_16x16x32_bf16 a[36:39], a[144:147], v[72:75], a[36:39]
    v_mfma_f32_16x16x32_bf16 a[40:43], a[144:147], v[80:83], a[40:43]
    v_mfma_f32_16x16x32_bf16 a[44:47], a[144:147], v[88:91], a[44:47]
    ds_read_b64_tr_b16 a[152:153], v8 offset:0
    ds_read_b64_tr_b16 a[154:155], v8 offset:4096
    s_waitcnt lgkmcnt(0)
    v_mfma_f32_16x16x32_bf16 a[48:51], a[152:155], v[64:67], a[48:51]
    v_mfma_f32_16x16x32_bf16 a[52:55], a[152:155], v[72:75], a[52:55]
    v_mfma_f32_16x16x32_bf16 a[56:59], a[152:155], v[80:83], a[56:59]
    v_mfma_f32_16x16x32_bf16 a[60:63], a[152:155], v[88:91], a[60:63]
    ds_read_b64_tr_b16 a[144:145], v9 offset:0
    ds_read_b64_tr_b16 a[146:147], v9 offset:4096
    s_waitcnt lgkmcnt(0)
    v_mfma_f32_16x16x32_bf16 a[64:67], a[144:147], v[64:67], a[64:67]
    v_mfma_f32_16x16x32_bf16 a[68:71], a[144:147], v[72:75], a[68:71]
    v_mfma_f32_16x16x32_bf16 a[72:75], a[144:147], v[80:83], a[72:75]
    v_mfma_f32_16x16x32_bf16 a[76:79], a[144:147], v[88:91], a[76:79]
    ds_read_b64_tr_b16 a[152:153], v10 offset:0
    ds_read_b64_tr_b16 a[154:155], v10 offset:4096
    s_waitcnt lgkmcnt(0)
    v_mfma_f32_16x16x32_bf16 a[80:83], a[152:155], v[64:67], a[80:83]
    v_mfma_f32_16x16x32_bf16 a[84:87], a[152:155], v[72:75], a[84:87]
    v_mfma_f32_16x16x32_bf16 a[88:91], a[152:155], v[80:83], a[88:91]
    v_mfma_f32_16x16x32_bf16 a[92:95], a[152:155], v[88:91], a[92:95]
    ds_read_b64_tr_b16 a[144:145], v11 offset:0
    ds_read_b64_tr_b16 a[146:147], v11 offset:4096
    s_waitcnt lgkmcnt(0)
    v_mfma_f32_16x16x32_bf16 a[96:99], a[144:147], v[64:67], a[96:99]
    v_mfma_f32_16x16x32_bf16 a[100:103], a[144:147], v[72:75], a[100:103]
    v_mfma_f32_16x16x32_bf16 a[104:107], a[144:147], v[80:83], a[104:107]
    v_mfma_f32_16x16x32_bf16 a[108:111], a[144:147], v[88:91], a[108:111]
    ds_read_b64_tr_b16 a[152:153], v12 offset:0
    ds_read_b64_tr_b16 a[154:155], v12 offset:4096
    s_waitcnt lgkmcnt(0)
    v_mfma_f32_16x16x32_bf16 a[112:115], a[152:155], v[64:67], a[112:115]
    v_mfma_f32_16x16x32_bf16 a[116:119], a[152:155], v[72:75], a[116:119]
    v_mfma_f32_16x16x32_bf16 a[120:123], a[152:155], v[80:83], a[120:123]
    v_mfma_f32_16x16x32_bf16 a[124:127], a[152:155], v[88:91], a[124:127]
    s_nop 7
    s_add_u32 s29, s29, 0x2000
    s_cmp_lt_u32 s29, 0x80000
    s_cbranch_scc1 L_sloop
    v_rcp_f32 v28, v144
    v_rcp_f32 v29, v145
    v_rcp_f32 v30, v146
    v_rcp_f32 v31, v147
    v_and_b32 v24, 15, v0
    v_lshlrev_b32 v152, 8, v24
    v_lshrrev_b32 v24, 5, v0
    v_lshl_add_u32 v152, v24, 6, v152
    v_bfe_u32 v24, v0, 4, 1
    v_lshl_add_u32 v152, v24, 3, v152
    s_lshl_b32 s31, s28, 14
    v_add_u32 v152, s31, v152
    v_accvgpr_read_b32 v32, a0
    v_accvgpr_read_b32 v33, a1
    v_accvgpr_read_b32 v34, a2
    v_accvgpr_read_b32 v35, a3
    v_mul_f32 v32, v32, v28
    v_mul_f32 v33, v33, v28
    v_mul_f32 v34, v34, v28
    v_mul_f32 v35, v35, v28
    v_cvt_pk_bf16_f32 v32, v32, v33
    v_cvt_pk_bf16_f32 v33, v34, v35
    buffer_store_dwordx2 v[32:33], v152, s[20:23], s36 offen offset:0
    v_accvgpr_read_b32 v36, a16
    v_accvgpr_read_b32 v37, a17
    v_accvgpr_read_b32 v38, a18
    v_accvgpr_read_b32 v39, a19
    v_mul_f32 v36, v36, v28
    v_mul_f32 v37, v37, v28
    v_mul_f32 v38, v38, v28
    v_mul_f32 v39, v39, v28
    v_cvt_pk_bf16_f32 v36, v36, v37
    v_cvt_pk_bf16_f32 v37, v38, v39
    buffer_store_dwordx2 v[36:37], v152, s[20:23], s36 offen offset:16
    v_accvgpr_read_b32 v40, a32
    v_accvgpr_read_b32 v41, a33
    v_accvgpr_read_b32 v42, a34
    v_accvgpr_read_b32 v43, a35
    v_mul_f32 v40, v40, v28
    v_mul_f32 v41, v41, v28
    v_mul_f32 v42, v42, v28
    v_mul_f32 v43, v43, v28
    v_cvt_pk_bf16_f32 v40, v40, v41
    v_cvt_pk_bf16_f32 v41, v42, v43
    buffer_store_dwordx2 v[40:41], v152, s[20:23], s36 offen offset:32
    v_accvgpr_read_b32 v44, a48
    v_accvgpr_read_b32 v45, a49
    v_accvgpr_read_b32 v46, a50
    v_accvgpr_read_b32 v47, a51
    v_mul_f32 v44, v44, v28
    v_mul_f32 v45, v45, v28
    v_mul_f32 v46, v46, v28
    v_mul_f32 v47, v47, v28
    v_cvt_pk_bf16_f32 v44, v44, v45
    v_cvt_pk_bf16_f32 v45, v46, v47
    buffer_store_dwordx2 v[44:45], v152, s[20:23], s36 offen offset:48
    v_accvgpr_read_b32 v48, a64
    v_accvgpr_read_b32 v49, a65
    v_accvgpr_read_b32 v50, a66
    v_accvgpr_read_b32 v51, a67
    v_mul_f32 v48, v48, v28
    v_mul_f32 v49, v49, v28
    v_mul_f32 v50, v50, v28
    v_mul_f32 v51, v51, v28
    v_cvt_pk_bf16_f32 v48, v48, v49
    v_cvt_pk_bf16_f32 v49, v50, v51
    buffer_store_dwordx2 v[48:49], v152, s[20:23], s36 offen offset:128
    v_accvgpr_read_b32 v52, a80
    v_accvgpr_read_b32 v53, a81
    v_accvgpr_read_b32 v54, a82
    v_accvgpr_read_b32 v55, a83
    v_mul_f32 v52, v52, v28
    v_mul_f32 v53, v53, v28
    v_mul_f32 v54, v54, v28
    v_mul_f32 v55, v55, v28
    v_cvt_pk_bf16_f32 v52, v52, v53
    v_cvt_pk_bf16_f32 v53, v54, v55
    buffer_store_dwordx2 v[52:53], v152, s[20:23], s36 offen offset:144
    v_accvgpr_read_b32 v56, a96
    v_accvgpr_read_b32 v57, a97
    v_accvgpr_read_b32 v58, a98
    v_accvgpr_read_b32 v59, a99
    v_mul_f32 v56, v56, v28
    v_mul_f32 v57, v57, v28
    v_mul_f32 v58, v58, v28
    v_mul_f32 v59, v59, v28
    v_cvt_pk_bf16_f32 v56, v56, v57
    v_cvt_pk_bf16_f32 v57, v58, v59
    buffer_store_dwordx2 v[56:57], v152, s[20:23], s36 offen offset:160
    v_accvgpr_read_b32 v60, a112
    v_accvgpr_read_b32 v61, a113
    v_accvgpr_read_b32 v62, a114
    v_accvgpr_read_b32 v63, a115
    v_mul_f32 v60, v60, v28
    v_mul_f32 v61, v61, v28
    v_mul_f32 v62, v62, v28
    v_mul_f32 v63, v63, v28
    v_cvt_pk_bf16_f32 v60, v60, v61
    v_cvt_pk_bf16_f32 v61, v62, v63
    buffer_store_dwordx2 v[60:61], v152, s[20:23], s36 offen offset:176
    s_waitcnt vmcnt(0)
    v_accvgpr_read_b32 v32, a4
    v_accvgpr_read_b32 v33, a5
    v_accvgpr_read_b32 v34, a6
    v_accvgpr_read_b32 v35, a7
    v_mul_f32 v32, v32, v29
    v_mul_f32 v33, v33, v29
    v_mul_f32 v34, v34, v29
    v_mul_f32 v35, v35, v29
    v_cvt_pk_bf16_f32 v32, v32, v33
    v_cvt_pk_bf16_f32 v33, v34, v35
    buffer_store_dwordx2 v[32:33], v152, s[20:23], s37 offen offset:0
    v_accvgpr_read_b32 v36, a20
    v_accvgpr_read_b32 v37, a21
    v_accvgpr_read_b32 v38, a22
    v_accvgpr_read_b32 v39, a23
    v_mul_f32 v36, v36, v29
    v_mul_f32 v37, v37, v29
    v_mul_f32 v38, v38, v29
    v_mul_f32 v39, v39, v29
    v_cvt_pk_bf16_f32 v36, v36, v37
    v_cvt_pk_bf16_f32 v37, v38, v39
    buffer_store_dwordx2 v[36:37], v152, s[20:23], s37 offen offset:16
    v_accvgpr_read_b32 v40, a36
    v_accvgpr_read_b32 v41, a37
    v_accvgpr_read_b32 v42, a38
    v_accvgpr_read_b32 v43, a39
    v_mul_f32 v40, v40, v29
    v_mul_f32 v41, v41, v29
    v_mul_f32 v42, v42, v29
    v_mul_f32 v43, v43, v29
    v_cvt_pk_bf16_f32 v40, v40, v41
    v_cvt_pk_bf16_f32 v41, v42, v43
    buffer_store_dwordx2 v[40:41], v152, s[20:23], s37 offen offset:32
    v_accvgpr_read_b32 v44, a52
    v_accvgpr_read_b32 v45, a53
    v_accvgpr_read_b32 v46, a54
    v_accvgpr_read_b32 v47, a55
    v_mul_f32 v44, v44, v29
    v_mul_f32 v45, v45, v29
    v_mul_f32 v46, v46, v29
    v_mul_f32 v47, v47, v29
    v_cvt_pk_bf16_f32 v44, v44, v45
    v_cvt_pk_bf16_f32 v45, v46, v47
    buffer_store_dwordx2 v[44:45], v152, s[20:23], s37 offen offset:48
    v_accvgpr_read_b32 v48, a68
    v_accvgpr_read_b32 v49, a69
    v_accvgpr_read_b32 v50, a70
    v_accvgpr_read_b32 v51, a71
    v_mul_f32 v48, v48, v29
    v_mul_f32 v49, v49, v29
    v_mul_f32 v50, v50, v29
    v_mul_f32 v51, v51, v29
    v_cvt_pk_bf16_f32 v48, v48, v49
    v_cvt_pk_bf16_f32 v49, v50, v51
    buffer_store_dwordx2 v[48:49], v152, s[20:23], s37 offen offset:128
    v_accvgpr_read_b32 v52, a84
    v_accvgpr_read_b32 v53, a85
    v_accvgpr_read_b32 v54, a86
    v_accvgpr_read_b32 v55, a87
    v_mul_f32 v52, v52, v29
    v_mul_f32 v53, v53, v29
    v_mul_f32 v54, v54, v29
    v_mul_f32 v55, v55, v29
    v_cvt_pk_bf16_f32 v52, v52, v53
    v_cvt_pk_bf16_f32 v53, v54, v55
    buffer_store_dwordx2 v[52:53], v152, s[20:23], s37 offen offset:144
    v_accvgpr_read_b32 v56, a100
    v_accvgpr_read_b32 v57, a101
    v_accvgpr_read_b32 v58, a102
    v_accvgpr_read_b32 v59, a103
    v_mul_f32 v56, v56, v29
    v_mul_f32 v57, v57, v29
    v_mul_f32 v58, v58, v29
    v_mul_f32 v59, v59, v29
    v_cvt_pk_bf16_f32 v56, v56, v57
    v_cvt_pk_bf16_f32 v57, v58, v59
    buffer_store_dwordx2 v[56:57], v152, s[20:23], s37 offen offset:160
    v_accvgpr_read_b32 v60, a116
    v_accvgpr_read_b32 v61, a117
    v_accvgpr_read_b32 v62, a118
    v_accvgpr_read_b32 v63, a119
    v_mul_f32 v60, v60, v29
    v_mul_f32 v61, v61, v29
    v_mul_f32 v62, v62, v29
    v_mul_f32 v63, v63, v29
    v_cvt_pk_bf16_f32 v60, v60, v61
    v_cvt_pk_bf16_f32 v61, v62, v63
    buffer_store_dwordx2 v[60:61], v152, s[20:23], s37 offen offset:176
    s_waitcnt vmcnt(0)
    v_accvgpr_read_b32 v32, a8
    v_accvgpr_read_b32 v33, a9
    v_accvgpr_read_b32 v34, a10
    v_accvgpr_read_b32 v35, a11
    v_mul_f32 v32, v32, v30
    v_mul_f32 v33, v33, v30
    v_mul_f32 v34, v34, v30
    v_mul_f32 v35, v35, v30
    v_cvt_pk_bf16_f32 v32, v32, v33
    v_cvt_pk_bf16_f32 v33, v34, v35
    buffer_store_dwordx2 v[32:33], v152, s[20:23], s38 offen offset:0
    v_accvgpr_read_b32 v36, a24
    v_accvgpr_read_b32 v37, a25
    v_accvgpr_read_b32 v38, a26
    v_accvgpr_read_b32 v39, a27
    v_mul_f32 v36, v36, v30
    v_mul_f32 v37, v37, v30
    v_mul_f32 v38, v38, v30
    v_mul_f32 v39, v39, v30
    v_cvt_pk_bf16_f32 v36, v36, v37
    v_cvt_pk_bf16_f32 v37, v38, v39
    buffer_store_dwordx2 v[36:37], v152, s[20:23], s38 offen offset:16
    v_accvgpr_read_b32 v40, a40
    v_accvgpr_read_b32 v41, a41
    v_accvgpr_read_b32 v42, a42
    v_accvgpr_read_b32 v43, a43
    v_mul_f32 v40, v40, v30
    v_mul_f32 v41, v41, v30
    v_mul_f32 v42, v42, v30
    v_mul_f32 v43, v43, v30
    v_cvt_pk_bf16_f32 v40, v40, v41
    v_cvt_pk_bf16_f32 v41, v42, v43
    buffer_store_dwordx2 v[40:41], v152, s[20:23], s38 offen offset:32
    v_accvgpr_read_b32 v44, a56
    v_accvgpr_read_b32 v45, a57
    v_accvgpr_read_b32 v46, a58
    v_accvgpr_read_b32 v47, a59
    v_mul_f32 v44, v44, v30
    v_mul_f32 v45, v45, v30
    v_mul_f32 v46, v46, v30
    v_mul_f32 v47, v47, v30
    v_cvt_pk_bf16_f32 v44, v44, v45
    v_cvt_pk_bf16_f32 v45, v46, v47
    buffer_store_dwordx2 v[44:45], v152, s[20:23], s38 offen offset:48
    v_accvgpr_read_b32 v48, a72
    v_accvgpr_read_b32 v49, a73
    v_accvgpr_read_b32 v50, a74
    v_accvgpr_read_b32 v51, a75
    v_mul_f32 v48, v48, v30
    v_mul_f32 v49, v49, v30
    v_mul_f32 v50, v50, v30
    v_mul_f32 v51, v51, v30
    v_cvt_pk_bf16_f32 v48, v48, v49
    v_cvt_pk_bf16_f32 v49, v50, v51
    buffer_store_dwordx2 v[48:49], v152, s[20:23], s38 offen offset:128
    v_accvgpr_read_b32 v52, a88
    v_accvgpr_read_b32 v53, a89
    v_accvgpr_read_b32 v54, a90
    v_accvgpr_read_b32 v55, a91
    v_mul_f32 v52, v52, v30
    v_mul_f32 v53, v53, v30
    v_mul_f32 v54, v54, v30
    v_mul_f32 v55, v55, v30
    v_cvt_pk_bf16_f32 v52, v52, v53
    v_cvt_pk_bf16_f32 v53, v54, v55
    buffer_store_dwordx2 v[52:53], v152, s[20:23], s38 offen offset:144
    v_accvgpr_read_b32 v56, a104
    v_accvgpr_read_b32 v57, a105
    v_accvgpr_read_b32 v58, a106
    v_accvgpr_read_b32 v59, a107
    v_mul_f32 v56, v56, v30
    v_mul_f32 v57, v57, v30
    v_mul_f32 v58, v58, v30
    v_mul_f32 v59, v59, v30
    v_cvt_pk_bf16_f32 v56, v56, v57
    v_cvt_pk_bf16_f32 v57, v58, v59
    buffer_store_dwordx2 v[56:57], v152, s[20:23], s38 offen offset:160
    v_accvgpr_read_b32 v60, a120
    v_accvgpr_read_b32 v61, a121
    v_accvgpr_read_b32 v62, a122
    v_accvgpr_read_b32 v63, a123
    v_mul_f32 v60, v60, v30
    v_mul_f32 v61, v61, v30
    v_mul_f32 v62, v62, v30
    v_mul_f32 v63, v63, v30
    v_cvt_pk_bf16_f32 v60, v60, v61
    v_cvt_pk_bf16_f32 v61, v62, v63
    buffer_store_dwordx2 v[60:61], v152, s[20:23], s38 offen offset:176
    s_waitcnt vmcnt(0)
    v_accvgpr_read_b32 v32, a12
    v_accvgpr_read_b32 v33, a13
    v_accvgpr_read_b32 v34, a14
    v_accvgpr_read_b32 v35, a15
    v_mul_f32 v32, v32, v31
    v_mul_f32 v33, v33, v31
    v_mul_f32 v34, v34, v31
    v_mul_f32 v35, v35, v31
    v_cvt_pk_bf16_f32 v32, v32, v33
    v_cvt_pk_bf16_f32 v33, v34, v35
    buffer_store_dwordx2 v[32:33], v152, s[20:23], s39 offen offset:0
    v_accvgpr_read_b32 v36, a28
    v_accvgpr_read_b32 v37, a29
    v_accvgpr_read_b32 v38, a30
    v_accvgpr_read_b32 v39, a31
    v_mul_f32 v36, v36, v31
    v_mul_f32 v37, v37, v31
    v_mul_f32 v38, v38, v31
    v_mul_f32 v39, v39, v31
    v_cvt_pk_bf16_f32 v36, v36, v37
    v_cvt_pk_bf16_f32 v37, v38, v39
    buffer_store_dwordx2 v[36:37], v152, s[20:23], s39 offen offset:16
    v_accvgpr_read_b32 v40, a44
    v_accvgpr_read_b32 v41, a45
    v_accvgpr_read_b32 v42, a46
    v_accvgpr_read_b32 v43, a47
    v_mul_f32 v40, v40, v31
    v_mul_f32 v41, v41, v31
    v_mul_f32 v42, v42, v31
    v_mul_f32 v43, v43, v31
    v_cvt_pk_bf16_f32 v40, v40, v41
    v_cvt_pk_bf16_f32 v41, v42, v43
    buffer_store_dwordx2 v[40:41], v152, s[20:23], s39 offen offset:32
    v_accvgpr_read_b32 v44, a60
    v_accvgpr_read_b32 v45, a61
    v_accvgpr_read_b32 v46, a62
    v_accvgpr_read_b32 v47, a63
    v_mul_f32 v44, v44, v31
    v_mul_f32 v45, v45, v31
    v_mul_f32 v46, v46, v31
    v_mul_f32 v47, v47, v31
    v_cvt_pk_bf16_f32 v44, v44, v45
    v_cvt_pk_bf16_f32 v45, v46, v47
    buffer_store_dwordx2 v[44:45], v152, s[20:23], s39 offen offset:48
    v_accvgpr_read_b32 v48, a76
    v_accvgpr_read_b32 v49, a77
    v_accvgpr_read_b32 v50, a78
    v_accvgpr_read_b32 v51, a79
    v_mul_f32 v48, v48, v31
    v_mul_f32 v49, v49, v31
    v_mul_f32 v50, v50, v31
    v_mul_f32 v51, v51, v31
    v_cvt_pk_bf16_f32 v48, v48, v49
    v_cvt_pk_bf16_f32 v49, v50, v51
    buffer_store_dwordx2 v[48:49], v152, s[20:23], s39 offen offset:128
    v_accvgpr_read_b32 v52, a92
    v_accvgpr_read_b32 v53, a93
    v_accvgpr_read_b32 v54, a94
    v_accvgpr_read_b32 v55, a95
    v_mul_f32 v52, v52, v31
    v_mul_f32 v53, v53, v31
    v_mul_f32 v54, v54, v31
    v_mul_f32 v55, v55, v31
    v_cvt_pk_bf16_f32 v52, v52, v53
    v_cvt_pk_bf16_f32 v53, v54, v55
    buffer_store_dwordx2 v[52:53], v152, s[20:23], s39 offen offset:144
    v_accvgpr_read_b32 v56, a108
    v_accvgpr_read_b32 v57, a109
    v_accvgpr_read_b32 v58, a110
    v_accvgpr_read_b32 v59, a111
    v_mul_f32 v56, v56, v31
    v_mul_f32 v57, v57, v31
    v_mul_f32 v58, v58, v31
    v_mul_f32 v59, v59, v31
    v_cvt_pk_bf16_f32 v56, v56, v57
    v_cvt_pk_bf16_f32 v57, v58, v59
    buffer_store_dwordx2 v[56:57], v152, s[20:23], s39 offen offset:160
    v_accvgpr_read_b32 v60, a124
    v_accvgpr_read_b32 v61, a125
    v_accvgpr_read_b32 v62, a126
    v_accvgpr_read_b32 v63, a127
    v_mul_f32 v60, v60, v31
    v_mul_f32 v61, v61, v31
    v_mul_f32 v62, v62, v31
    v_mul_f32 v63, v63, v31
    v_cvt_pk_bf16_f32 v60, v60, v61
    v_cvt_pk_bf16_f32 v61, v62, v63
    buffer_store_dwordx2 v[60:61], v152, s[20:23], s39 offen offset:176
    s_waitcnt vmcnt(0)
    s_branch L_done
.section .rodata,"a"
.p2align 6
.amdhsa_kernel standalone__gqa_softmax__near_ridge_kernel
  .amdhsa_next_free_vgpr 432
  .amdhsa_next_free_sgpr 102
  .amdhsa_accum_offset 256
  .amdhsa_group_segment_fixed_size 0
  .amdhsa_kernarg_size 48
  .amdhsa_user_sgpr_count 2
  .amdhsa_user_sgpr_kernarg_segment_ptr 1
  .amdhsa_system_sgpr_workgroup_id_x 1
  .amdhsa_float_denorm_mode_32 3
.end_amdhsa_kernel
```
